```python
import torch

def _softmax(x, axis=-1):
    return torch.softmax(x, dim=axis)

def _gelu(x):
    return torch.nn.functional.gelu(x, approximate='tanh')

def _silu(x):
    return torch.nn.functional.silu(x)

def _sigmoid(x):
    return torch.sigmoid(x)

def _layernorm(x, axis=-1, eps=1e-05):
    m = x.mean(dim=axis, keepdim=True)
    v = x.var(dim=axis, keepdim=True, unbiased=False)
    return (x - m) / torch.sqrt(v + eps)

def _scatter_add(tgt, idx, src, axis=0):
    return tgt.clone().index_add_(axis, idx, src)

def _segment_sum(src, seg, n):
    out = torch.zeros((n,) + src.shape[1:], dtype=src.dtype)
    return out.index_add_(0, seg, src)

def _pad(x, pw):
    flat = tuple((v for pair in reversed(pw) for v in pair))
    return torch.nn.functional.pad(x, flat)
kernel_name = 'adaLN_cond__sliding_block_cached__glu_gated_swiglu__decode'

def setup_inputs():

    _w = lambda a: (lambda t: t.to(torch.bfloat16) if t.is_floating_point() else t)(torch.as_tensor(a))

    def _A_setup():
        B, Sq, D = (4, 1, 512)
        Hq, Hkv, Sk, Dh = (32, 8, 4096, 128)
        assert Hq % Hkv == 0, (Hq, Hkv)
        return {'x': _w((lambda *s: torch.randn(*s, dtype=torch.bfloat16) * 0.1)(B, Sq, D)), 'k_cache': _w((lambda *s: torch.randn(*s, dtype=torch.bfloat16) * 0.8)(B, Hkv, Sk, Dh)), 'v_cache': _w((lambda *s: torch.randn(*s, dtype=torch.bfloat16) * 3.2)(B, Hkv, Sk, Dh)), 'wq': _w((lambda *s: torch.randn(*s, dtype=torch.bfloat16) * 0.8)(D, Hq * Dh) * D ** (-0.5)), 'wo': _w((lambda *s: torch.randn(*s, dtype=torch.bfloat16) * 3.2)(Hq * Dh, D) * (Hq * Dh) ** (-0.5))}
    _A_in = _A_setup()

    def _B_setup():
        B, S, D, F = (4, 1, 512, 1792)
        return {'x': _w((lambda *s: torch.randn(*s, dtype=torch.bfloat16) * 0.1)(B, S, D)), 'w1': _w((lambda *s: torch.randn(*s, dtype=torch.bfloat16) * 3.2)(D, F) * (2.0 / D) ** 0.5), 'w3': _w((lambda *s: torch.randn(*s, dtype=torch.bfloat16) * 3.2)(D, F) * (2.0 / D) ** 0.5), 'w2': _w((lambda *s: torch.randn(*s, dtype=torch.bfloat16) * 3.2)(F, D) * (2.0 / F) ** 0.5)}
    _B_in = _B_setup()
    return {'A_x': _A_in['x'], 'A_k_cache': _A_in['k_cache'], 'A_v_cache': _A_in['v_cache'], 'A_wq': _A_in['wq'], 'A_wo': _A_in['wo'], 'B_x': _B_in['x'], 'B_w1': _B_in['w1'], 'B_w3': _B_in['w3'], 'B_w2': _B_in['w2'], 'c': _w((lambda *s: torch.randn(*s, dtype=torch.bfloat16) * 0.8)(4, 512) * 8.0), 'w_mod': _w((lambda *s: torch.randn(*s, dtype=torch.bfloat16) * 0.8)(512, 6 * 512) * 512 ** (-0.5) * 8.0)}

def reference(A_x, A_k_cache, A_v_cache, A_wq, A_wo, B_x, B_w1, B_w3, B_w2, c, w_mod):

    def _A_ref(x, k_cache, v_cache, wq, wo):
        B, Sq, D = x.shape
        Hq, Dh = (32, 128)
        Hkv, Sk = (k_cache.shape[1], k_cache.shape[2])
        W = min(4096, max(256, Sk // 4))
        rep = Hq // Hkv
        q = (lambda x, *d: x.permute(*d))((x @ wq).reshape(B, Sq, Hq, Dh), 0, 2, 1, 3)
        k = (lambda x, n, axis: torch.repeat_interleave(x, n, dim=axis))(k_cache[:, :, Sk - W:, :], rep, axis=1)
        v = (lambda x, n, axis: torch.repeat_interleave(x, n, dim=axis))(v_cache[:, :, Sk - W:, :], rep, axis=1)
        scores = torch.einsum('bhqd,bhkd->bhqk', q, k) * Dh ** (-0.5)
        p = _softmax(scores, axis=-1)
        o = torch.einsum('bhqk,bhkd->bhqd', p, v)
        return (lambda x, *d: x.permute(*d))(o, 0, 2, 1, 3).reshape(B, Sq, Hq * Dh) @ wo

    def _B_ref(x, w1, w3, w2):
        gate = torch.einsum('bsd,df->bsf', x, w1)
        up = torch.einsum('bsd,df->bsf', x, w3)
        h = _silu(gate) * up
        out = torch.einsum('bsf,fd->bsd', h, w2)
        return out
    x = A_x
    mod = (_silu(c) @ w_mod).reshape(c.shape[0], 6, 1, -1)
    sa, ca, ga, sb, cb, gb = (mod[:, 0].clone(), mod[:, 1].clone(), mod[:, 2].clone(), mod[:, 3].clone(), mod[:, 4].clone(), mod[:, 5].clone())
    h = _layernorm(x, axis=-1) * (1 + ca) + sa
    x = x + ga * _A_ref(h, A_k_cache, A_v_cache, A_wq, A_wo)
    h = _layernorm(x, axis=-1) * (1 + cb) + sb
    x = x + gb * _B_ref(h, B_w1, B_w3, B_w2)
    return x
```

```asm
; @launch grid=(256,1,1) block=(256,1,1) lds=79104
.amdgcn_target "amdgcn-amd-amdhsa--gfx950"
.text
.globl adaLN_cond__sliding_block_cached__glu_gated_swiglu__decode_kernel
.p2align 12
.type adaLN_cond__sliding_block_cached__glu_gated_swiglu__decode_kernel,@function
adaLN_cond__sliding_block_cached__glu_gated_swiglu__decode_kernel:
    s_load_dwordx2 s[16:17], s[0:1], 8
    s_load_dwordx2 s[20:21], s[0:1], 16
    s_load_dwordx2 s[24:25], s[0:1], 24
    s_load_dwordx2 s[48:49], s[0:1], 80
    s_load_dwordx2 s[12:13], s[0:1], 0
    s_load_dwordx2 s[44:45], s[0:1], 72
    s_load_dwordx2 s[8:9], s[0:1], 104
    s_cmp_ge_u32 s2, 256
    s_cbranch_scc1 L_exit
    v_lshrrev_b32 v1, 6, v0
    v_and_b32 v0, 63, v0
    s_and_b32 s5, s2, 7
    v_readfirstlane_b32 s3, v1
    s_lshr_b32 s6, s2, 3
    s_sub_u32 s7, s6, 12
    s_cmp_lt_u32 s7, 16
    s_cbranch_scc1 L_A1
    s_mov_b32 s39, 0
    s_sub_u32 s59, s6, 4
    s_lshl3_add_u32 s60, s5, s59
    s_lshl2_add_u32 s62, s5, s7
    s_movk_i32 s50, 6144
    s_sub_u32 s38, s6, 28
    s_cmp_lt_u32 s59, 8
    s_cselect_b32 s51, 1, 0
    s_cselect_b32 s62, s60, s62
    s_cselect_b32 s50, 8192, s50
    s_lshl_b32 s35, s62, 7
    s_mov_b32 s34, 3
    s_cmp_lt_u32 s6, 4
    s_cbranch_scc0 L_S_wide
    s_lshl2_add_u32 s62, s5, s6
    s_lshl_b32 s35, s62, 6
    s_mov_b32 s34, 2
    s_mov_b32 s51, 2
L_S_wide:
    s_lshl_b32 s26, s50, 9
    s_mov_b32 s27, 0x20000
    s_mov_b32 s14, 0x1000
    s_mov_b32 s15, 0x20000
    s_mov_b32 s46, 0x1000
    s_mov_b32 s47, 0x20000
    v_and_b32 v10, 15, v0
    v_lshrrev_b32 v8, s34, v10
    v_lshlrev_b32 v11, s34, v8
    v_sub_u32 v10, v10, v11
    v_lshrrev_b32 v9, 4, v0
    v_lshl_add_u32 v8, v8, 2, v9
    v_lshlrev_b32 v10, 4, v10
    s_lshl_b32 s60, s50, 3
    v_mad_u32_u24 v3, v8, s60, v10
    s_lshl_b32 s60, s3, 7
    s_mul_i32 s59, s60, s50
    s_add_u32 s59, s59, s35
    v_and_b32 v11, 3, v0
    v_lshl_add_u32 v11, v11, 2, v9
    v_lshlrev_b32 v11, 4, v11
    s_mul_i32 s61, s50, 57
    v_and_b32 v8, 1, v0
    v_lshl_add_u32 v8, v8, 2, v9
    v_lshlrev_b32 v8, 3, v8
    v_and_b32 v9, 2, v0
    v_lshl_add_u32 v8, v9, 1, v8
    v_add_u32 v1, s60, v8
    v_bfe_u32 v2, v0, 2, 2
    v_lshlrev_b32 v8, 1, v1
    v_lshl_add_u32 v8, v2, 10, v8
    v_lshlrev_b32 v9, 4, v0
    s_lshl_b32 s60, s3, 10
    v_lshl_add_u32 v11, v2, 10, v11
    s_lshl_b32 s35, s3, 8
    s_cmp_eq_u32 s51, 1
    s_waitcnt lgkmcnt(0)
    s_cselect_b64 s[24:25], s[24:25], s[48:49]
    s_cmp_eq_u32 s51, 2
    s_cbranch_scc0 L_S_w2
    buffer_load_dwordx4 v[28:31], v11, s[44:47], s35 offen
    buffer_load_dwordx4 v[36:39], v3, s[24:27], s59 offen
    s_add_u32 s59, s59, s50
    buffer_load_dwordx4 v[40:43], v3, s[24:27], s59 offen
    s_add_u32 s59, s59, s50
    buffer_load_dwordx4 v[44:47], v3, s[24:27], s59 offen
    s_add_u32 s59, s59, s50
    buffer_load_dwordx4 v[48:51], v3, s[24:27], s59 offen
    s_add_u32 s59, s59, s50
    buffer_load_dwordx4 v[52:55], v3, s[24:27], s59 offen
    s_add_u32 s59, s59, s50
    buffer_load_dwordx4 v[56:59], v3, s[24:27], s59 offen
    s_add_u32 s59, s59, s50
    buffer_load_dwordx4 v[60:63], v3, s[24:27], s59 offen
    s_add_u32 s59, s59, s50
    buffer_load_dwordx4 v[64:67], v3, s[24:27], s59 offen
    s_branch L_S_ld_done
L_S_w2:
    s_cmp_eq_u32 s51, 1
    s_cbranch_scc1 L_S_qx
    buffer_load_dwordx2 v[24:25], v8, s[44:47], 0 offen
    buffer_load_dwordx2 v[26:27], v8, s[44:47], 0 offen offset:128
    s_branch L_S_mw
L_S_qx:
    buffer_load_dwordx2 v[20:21], v8, s[12:15], 0 offen
    buffer_load_dwordx2 v[22:23], v8, s[12:15], 0 offen offset:128
    buffer_load_dwordx4 v[28:31], v9, s[12:15], s60 offen
L_S_mw:
    buffer_load_dwordx4 v[36:39], v3, s[24:27], s59 offen
    s_add_u32 s59, s59, s50
    buffer_load_dwordx4 v[40:43], v3, s[24:27], s59 offen
    s_add_u32 s59, s59, s50
    buffer_load_dwordx4 v[44:47], v3, s[24:27], s59 offen
    s_add_u32 s59, s59, s50
    buffer_load_dwordx4 v[48:51], v3, s[24:27], s59 offen
    s_add_u32 s59, s59, s50
    buffer_load_dwordx4 v[52:55], v3, s[24:27], s59 offen
    s_add_u32 s59, s59, s50
    buffer_load_dwordx4 v[56:59], v3, s[24:27], s59 offen
    s_add_u32 s59, s59, s50
    buffer_load_dwordx4 v[60:63], v3, s[24:27], s59 offen
    s_add_u32 s59, s59, s50
    buffer_load_dwordx4 v[64:67], v3, s[24:27], s59 offen
    s_add_u32 s59, s59, s61
    buffer_load_dwordx4 v[68:71], v3, s[24:27], s59 offen
    s_add_u32 s59, s59, s50
    buffer_load_dwordx4 v[72:75], v3, s[24:27], s59 offen
    s_add_u32 s59, s59, s50
    buffer_load_dwordx4 v[76:79], v3, s[24:27], s59 offen
    s_add_u32 s59, s59, s50
    buffer_load_dwordx4 v[80:83], v3, s[24:27], s59 offen
    s_add_u32 s59, s59, s50
    buffer_load_dwordx4 v[84:87], v3, s[24:27], s59 offen
    s_add_u32 s59, s59, s50
    buffer_load_dwordx4 v[88:91], v3, s[24:27], s59 offen
    s_add_u32 s59, s59, s50
    buffer_load_dwordx4 v[92:95], v3, s[24:27], s59 offen
    s_add_u32 s59, s59, s50
    buffer_load_dwordx4 v[96:99], v3, s[24:27], s59 offen
L_S_ld_done:
    s_mov_b64 exec, 0
    s_cmp_eq_u32 s3, 0
    s_cbranch_scc1 L_pad_0
    s_cmp_eq_u32 s3, 1
    s_cbranch_scc1 L_pad_1
    s_cmp_eq_u32 s3, 2
    s_cbranch_scc1 L_pad_2
    s_cmp_eq_u32 s3, 3
    s_cbranch_scc1 L_pad_3
    s_branch L_warm_done
L_A1:
    s_mov_b32 s39, 1
    s_lshr_b32 s59, s7, 2
    s_lshl3_add_u32 s60, s59, s5
    s_lshl_b32 s60, s60, 4
    s_and_b32 s61, s7, 3
    s_add_u32 s60, s60, s61
    s_lshl2_add_u32 s60, s60, s3
    s_lshl_b32 s60, s60, 14
    s_add_u32 s60, s60, 0xC0000
    s_movk_i32 s62, 4096
    s_mov_b32 s61, s60
    v_lshlrev_b32 v7, 4, v0
    s_mov_b32 s18, 0x2000000
    s_mov_b32 s19, 0x20000
    s_mov_b32 s22, 0x2000000
    s_mov_b32 s23, 0x20000
    s_mov_b32 s46, s60
    s_waitcnt lgkmcnt(0)
    s_add_u32 s47, s46, 0
    buffer_load_dwordx4 a[0:3], v7, s[16:19], s47 offen offset:0 nt
    buffer_load_dwordx4 a[4:7], v7, s[16:19], s47 offen offset:1024 nt
    buffer_load_dwordx4 a[8:11], v7, s[16:19], s47 offen offset:2048 nt
    buffer_load_dwordx4 a[12:15], v7, s[16:19], s47 offen offset:3072 nt
    s_add_u32 s47, s46, 4096
    buffer_load_dwordx4 a[16:19], v7, s[16:19], s47 offen offset:0 nt
    buffer_load_dwordx4 a[20:23], v7, s[16:19], s47 offen offset:1024 nt
    buffer_load_dwordx4 a[24:27], v7, s[16:19], s47 offen offset:2048 nt
    buffer_load_dwordx4 a[28:31], v7, s[16:19], s47 offen offset:3072 nt
    s_add_u32 s47, s46, 8192
    buffer_load_dwordx4 a[32:35], v7, s[16:19], s47 offen offset:0 nt
    buffer_load_dwordx4 a[36:39], v7, s[16:19], s47 offen offset:1024 nt
    buffer_load_dwordx4 a[40:43], v7, s[16:19], s47 offen offset:2048 nt
    buffer_load_dwordx4 a[44:47], v7, s[16:19], s47 offen offset:3072 nt
    s_mov_b64 exec, 0
    s_cmp_eq_u32 s3, 0
    s_cbranch_scc1 L_pad_9
    s_cmp_eq_u32 s3, 1
    s_cbranch_scc1 L_pad_10
    s_cmp_eq_u32 s3, 2
    s_cbranch_scc1 L_pad_11
    s_cmp_eq_u32 s3, 3
    s_cbranch_scc1 L_pad_12
L_warm_done:
    s_mov_b64 exec, -1
    s_mov_b32 s56, 0x05040100
    s_mov_b32 s57, 0x07060302
    s_mov_b32 s58, 0x80000
    s_mov_b32 s10, 0x480000
    s_mov_b32 s11, 0x20000
    s_sub_u32 s7, s6, 12
    s_cmp_eq_u32 s39, 1
    s_cbranch_scc1 L_A
L_S:
    s_load_dwordx2 s[32:33], s[0:1], 48
    s_load_dwordx2 s[36:37], s[0:1], 56
L_pad_0:
    s_cbranch_execz L_pad_4
    s_load_dwordx2 s[40:41], s[0:1], 64
    s_load_dword s4, s[8:9], 0
    v_lshlrev_b32 v6, 4, v0
    s_lshl_b32 s7, s3, 10
    v_add_u32 v6, s7, v6
    v_add_lshl_u32 v4, v1, v2, 4
    s_and_b32 s7, s5, 3
    s_mul_i32 s7, s7, 0x2100
    v_add_u32 v4, s7, v4
    v_add_u32 v11, 0x40000, v4
    v_add_u32 v10, 0x20000, v4
    s_sub_u32 s60, s6, 25
    s_cmp_lt_u32 s6, 4
    s_cselect_b32 s63, s6, s60
    s_waitcnt lgkmcnt(0)
    s_mul_i32 s4, s4, 0x9E3779B1
    s_add_u32 s4, s4, 0x7F4A7C15
    v_mov_b32 v5, s4
    s_cmp_eq_u32 s51, 2
    s_cbranch_scc0 L_S_notn
    v_lshrrev_b32 v8, 4, v0
    v_lshlrev_b32 v12, 7, v8
    v_and_b32 v9, 3, v0
    v_lshl_add_u32 v12, v9, 5, v12
    v_lshl_add_u32 v12, v2, 3, v12
    s_lshl_b32 s7, s3, 9
    v_add_u32 v12, s7, v12
    v_and_b32 v13, 31, v0
    v_lshlrev_b32 v13, 4, v13
    v_and_b32 v8, 7, v0
    v_lshlrev_b32 v7, 6, v8
    v_bfe_u32 v8, v0, 3, 2
    v_lshl_add_u32 v7, v8, 4, v7
    v_lshrrev_b32 v8, 5, v0
    s_movk_i32 s7, 0x4200
    v_mad_u32_u24 v7, v8, s7, v7
    s_and_b32 s59, s62, 15
    s_lshl_b32 s59, s59, 9
    s_lshr_b32 s60, s62, 4
    s_lshl_b32 s61, s60, 17
    s_add_u32 s59, s59, s61
    s_add_u32 s59, s59, 0x20000
    v_add_u32 v7, s59, v7
    s_cmp_eq_u32 s60, 1
    s_cselect_b32 s64, 1.0, 0
    s_movk_i32 s59, 0x2100
    s_waitcnt vmcnt(8)
    v_lshlrev_b32 v196, 16, v28
    v_and_b32 v197, 0xffff0000, v28
    v_lshlrev_b32 v198, 16, v29
    v_and_b32 v199, 0xffff0000, v29
    v_lshlrev_b32 v200, 16, v30
    v_and_b32 v201, 0xffff0000, v30
    v_lshlrev_b32 v202, 16, v31
    v_and_b32 v203, 0xffff0000, v31
    v_mul_f32 v220, 0x3fb8aa3b, v196
    v_mul_f32 v221, 0x3fb8aa3b, v197
    v_mul_f32 v222, 0x3fb8aa3b, v198
    v_mul_f32 v223, 0x3fb8aa3b, v199
    v_mul_f32 v224, 0x3fb8aa3b, v200
    v_mul_f32 v225, 0x3fb8aa3b, v201
    v_mul_f32 v226, 0x3fb8aa3b, v202
    v_mul_f32 v227, 0x3fb8aa3b, v203
    v_exp_f32 v220, -v220
    v_exp_f32 v221, -v221
    v_exp_f32 v222, -v222
    v_exp_f32 v223, -v223
    v_exp_f32 v224, -v224
    v_exp_f32 v225, -v225
    v_exp_f32 v226, -v226
    v_exp_f32 v227, -v227
    v_add_f32 v220, 1.0, v220
    v_add_f32 v221, 1.0, v221
    v_add_f32 v222, 1.0, v222
    v_add_f32 v223, 1.0, v223
    v_add_f32 v224, 1.0, v224
    v_add_f32 v225, 1.0, v225
    v_add_f32 v226, 1.0, v226
    v_add_f32 v227, 1.0, v227
    v_rcp_f32 v228, v220
    v_rcp_f32 v229, v221
    v_rcp_f32 v230, v222
    v_rcp_f32 v231, v223
    v_rcp_f32 v232, v224
    v_rcp_f32 v233, v225
    v_rcp_f32 v234, v226
    v_rcp_f32 v235, v227
    v_min_f32 v220, 0x7f000000, v220
    v_min_f32 v221, 0x7f000000, v221
    v_min_f32 v222, 0x7f000000, v222
    v_min_f32 v223, 0x7f000000, v223
    v_min_f32 v224, 0x7f000000, v224
    v_min_f32 v225, 0x7f000000, v225
    v_min_f32 v226, 0x7f000000, v226
    v_min_f32 v227, 0x7f000000, v227
    v_mul_f32 v236, v196, v228
    v_fma_f32 v220, -v236, v220, v196
    v_fma_f32 v196, v220, v228, v236
    v_mul_f32 v236, v197, v229
    v_fma_f32 v221, -v236, v221, v197
    v_fma_f32 v197, v221, v229, v236
    v_mul_f32 v236, v198, v230
    v_fma_f32 v222, -v236, v222, v198
    v_fma_f32 v198, v222, v230, v236
    v_mul_f32 v236, v199, v231
    v_fma_f32 v223, -v236, v223, v199
    v_fma_f32 v199, v223, v231, v236
    v_mul_f32 v236, v200, v232
    v_fma_f32 v224, -v236, v224, v200
    v_fma_f32 v200, v224, v232, v236
    v_mul_f32 v236, v201, v233
    v_fma_f32 v225, -v236, v225, v201
    v_fma_f32 v201, v225, v233, v236
    v_mul_f32 v236, v202, v234
    v_fma_f32 v226, -v236, v226, v202
    v_fma_f32 v202, v226, v234, v236
    v_mul_f32 v236, v203, v235
    v_fma_f32 v227, -v236, v227, v203
    v_fma_f32 v203, v227, v235, v236
    v_cvt_pk_bf16_f32 v16, v196, v197
    v_cvt_pk_bf16_f32 v17, v198, v199
    v_cvt_pk_bf16_f32 v18, v200, v201
    v_cvt_pk_bf16_f32 v19, v202, v203
    v_mov_b32 v226, 0
    v_mov_b32 v227, v5
    s_waitcnt vmcnt(6)
    v_perm_b32 v100, v40, v36, s56
    v_perm_b32 v104, v40, v36, s57
    v_perm_b32 v108, v41, v37, s56
    v_perm_b32 v112, v41, v37, s57
    v_perm_b32 v116, v42, v38, s56
    v_perm_b32 v120, v42, v38, s57
    v_perm_b32 v124, v43, v39, s56
    v_perm_b32 v128, v43, v39, s57
    s_waitcnt vmcnt(4)
    v_perm_b32 v101, v48, v44, s56
    v_perm_b32 v105, v48, v44, s57
    v_perm_b32 v109, v49, v45, s56
    v_perm_b32 v113, v49, v45, s57
    v_perm_b32 v117, v50, v46, s56
    v_perm_b32 v121, v50, v46, s57
    v_perm_b32 v125, v51, v47, s56
    v_perm_b32 v129, v51, v47, s57
    s_waitcnt vmcnt(2)
    v_perm_b32 v102, v56, v52, s56
    v_perm_b32 v106, v56, v52, s57
    v_perm_b32 v110, v57, v53, s56
    v_perm_b32 v114, v57, v53, s57
    v_perm_b32 v118, v58, v54, s56
    v_perm_b32 v122, v58, v54, s57
    v_perm_b32 v126, v59, v55, s56
    v_perm_b32 v130, v59, v55, s57
    s_waitcnt vmcnt(0)
    v_perm_b32 v103, v64, v60, s56
    v_perm_b32 v107, v64, v60, s57
    v_perm_b32 v111, v65, v61, s56
    v_perm_b32 v115, v65, v61, s57
    v_perm_b32 v119, v66, v62, s56
    v_perm_b32 v123, v66, v62, s57
    v_perm_b32 v127, v67, v63, s56
    v_perm_b32 v131, v67, v63, s57
    s_nop 1
    v_mfma_f32_16x16x32_bf16 v[164:167], v[16:19], v[100:103], 0
    v_mfma_f32_16x16x32_bf16 v[168:171], v[16:19], v[104:107], 0
    v_mfma_f32_16x16x32_bf16 v[172:175], v[16:19], v[108:111], 0
    v_mfma_f32_16x16x32_bf16 v[176:179], v[16:19], v[112:115], 0
    v_mfma_f32_16x16x32_bf16 v[180:183], v[16:19], v[116:119], 0
    v_mfma_f32_16x16x32_bf16 v[184:187], v[16:19], v[120:123], 0
    v_mfma_f32_16x16x32_bf16 v[188:191], v[16:19], v[124:127], 0
    v_mfma_f32_16x16x32_bf16 v[192:195], v[16:19], v[128:131], 0
L_pad_1:
    s_cbranch_execz L_pad_5
    s_nop 0
    v_mov_b32_dpp v220, v164 quad_perm:[0,1,2,3] row_mask:0xf bank_mask:0x1
    v_mov_b32_dpp v221, v168 quad_perm:[0,1,2,3] row_mask:0xf bank_mask:0x1
    v_mov_b32_dpp v220, v173 quad_perm:[0,1,2,3] row_mask:0xf bank_mask:0x2
    v_mov_b32_dpp v221, v177 quad_perm:[0,1,2,3] row_mask:0xf bank_mask:0x2
    v_mov_b32_dpp v220, v182 quad_perm:[0,1,2,3] row_mask:0xf bank_mask:0x4
    v_mov_b32_dpp v221, v186 quad_perm:[0,1,2,3] row_mask:0xf bank_mask:0x4
    v_mov_b32_dpp v220, v191 quad_perm:[0,1,2,3] row_mask:0xf bank_mask:0x8
    v_mov_b32_dpp v221, v195 quad_perm:[0,1,2,3] row_mask:0xf bank_mask:0x8
    v_add_f32_dpp v220, v165, v220 row_shl:4 row_mask:0xf bank_mask:0x1
    v_add_f32_dpp v221, v169, v221 row_shl:4 row_mask:0xf bank_mask:0x1
    v_add_f32_dpp v220, v174, v220 row_shl:4 row_mask:0xf bank_mask:0x2
    v_add_f32_dpp v221, v178, v221 row_shl:4 row_mask:0xf bank_mask:0x2
    v_add_f32_dpp v220, v183, v220 row_shl:4 row_mask:0xf bank_mask:0x4
    v_add_f32_dpp v221, v187, v221 row_shl:4 row_mask:0xf bank_mask:0x4
    v_add_f32_dpp v220, v188, v220 row_shr:12 row_mask:0xf bank_mask:0x8
    v_add_f32_dpp v221, v192, v221 row_shr:12 row_mask:0xf bank_mask:0x8
    v_add_f32_dpp v220, v166, v220 row_shl:8 row_mask:0xf bank_mask:0x1
    v_add_f32_dpp v221, v170, v221 row_shl:8 row_mask:0xf bank_mask:0x1
    v_add_f32_dpp v220, v175, v220 row_shl:8 row_mask:0xf bank_mask:0x2
    v_add_f32_dpp v221, v179, v221 row_shl:8 row_mask:0xf bank_mask:0x2
    v_add_f32_dpp v220, v180, v220 row_shr:8 row_mask:0xf bank_mask:0x4
    v_add_f32_dpp v221, v184, v221 row_shr:8 row_mask:0xf bank_mask:0x4
    v_add_f32_dpp v220, v189, v220 row_shr:8 row_mask:0xf bank_mask:0x8
    v_add_f32_dpp v221, v193, v221 row_shr:8 row_mask:0xf bank_mask:0x8
    v_add_f32_dpp v220, v167, v220 row_shl:12 row_mask:0xf bank_mask:0x1
    v_add_f32_dpp v221, v171, v221 row_shl:12 row_mask:0xf bank_mask:0x1
    v_add_f32_dpp v220, v172, v220 row_shr:4 row_mask:0xf bank_mask:0x2
    v_add_f32_dpp v221, v176, v221 row_shr:4 row_mask:0xf bank_mask:0x2
    v_add_f32_dpp v220, v181, v220 row_shr:4 row_mask:0xf bank_mask:0x4
    v_add_f32_dpp v221, v185, v221 row_shr:4 row_mask:0xf bank_mask:0x4
    v_add_f32_dpp v220, v190, v220 row_shr:4 row_mask:0xf bank_mask:0x8
    v_add_f32_dpp v221, v194, v221 row_shr:4 row_mask:0xf bank_mask:0x8
    ds_write_b64 v12, v[220:221] offset:0
    s_waitcnt lgkmcnt(0)
    s_barrier
    s_cmp_lg_u32 s3, 0
    s_cbranch_scc1 L_S_post
    ds_read_b128 v[228:231], v13 offset:0
    ds_read_b128 v[232:235], v13 offset:512
    ds_read_b128 v[236:239], v13 offset:1024
    ds_read_b128 v[240:243], v13 offset:1536
    s_waitcnt lgkmcnt(0)
    v_pk_add_f32 v[220:221], v[228:229], v[232:233]
    v_pk_add_f32 v[222:223], v[230:231], v[234:235]
    v_pk_add_f32 v[236:237], v[236:237], v[240:241]
    v_pk_add_f32 v[238:239], v[238:239], v[242:243]
    v_pk_add_f32 v[220:221], v[220:221], v[236:237]
    v_pk_add_f32 v[222:223], v[222:223], v[238:239]
    v_cvt_pk_bf16_f32 v224, v220, v221
    v_lshlrev_b32 v220, 16, v224
    v_and_b32 v221, 0xffff0000, v224
    v_cvt_pk_bf16_f32 v225, v222, v223
    v_lshlrev_b32 v222, 16, v225
    v_and_b32 v223, 0xffff0000, v225
    v_add_f32 v220, s64, v220
    v_add_f32 v221, s64, v221
    v_add_f32 v222, s64, v222
    v_add_f32 v223, s64, v223
    v_cvt_pk_bf16_f32 v224, v220, v221
    v_cvt_pk_bf16_f32 v225, v222, v223
    buffer_store_dwordx4 v[224:227], v7, s[8:11], 0 offen sc1
    buffer_store_dwordx4 v[224:227], v7, s[8:11], s59 offen sc1
    s_branch L_S_post
L_S_notn:
L_S_strip:
    s_cmp_lg_u32 s51, 0
    s_cbranch_scc1 L_Q
    s_waitcnt vmcnt(16)
    v_lshlrev_b32 v196, 16, v24
    v_and_b32 v197, 0xffff0000, v24
    v_lshlrev_b32 v198, 16, v25
    v_and_b32 v199, 0xffff0000, v25
    v_lshlrev_b32 v200, 16, v26
    v_and_b32 v201, 0xffff0000, v26
    v_lshlrev_b32 v202, 16, v27
    v_and_b32 v203, 0xffff0000, v27
    v_mul_f32 v220, 0x3fb8aa3b, v196
    v_mul_f32 v221, 0x3fb8aa3b, v197
    v_mul_f32 v222, 0x3fb8aa3b, v198
    v_mul_f32 v223, 0x3fb8aa3b, v199
    v_mul_f32 v224, 0x3fb8aa3b, v200
    v_mul_f32 v225, 0x3fb8aa3b, v201
    v_mul_f32 v226, 0x3fb8aa3b, v202
    v_mul_f32 v227, 0x3fb8aa3b, v203
    v_exp_f32 v220, -v220
    v_exp_f32 v221, -v221
    v_exp_f32 v222, -v222
    v_exp_f32 v223, -v223
    v_exp_f32 v224, -v224
    v_exp_f32 v225, -v225
    v_exp_f32 v226, -v226
    v_exp_f32 v227, -v227
    v_add_f32 v220, 1.0, v220
    v_add_f32 v221, 1.0, v221
    v_add_f32 v222, 1.0, v222
    v_add_f32 v223, 1.0, v223
    v_add_f32 v224, 1.0, v224
    v_add_f32 v225, 1.0, v225
    v_add_f32 v226, 1.0, v226
    v_add_f32 v227, 1.0, v227
    v_rcp_f32 v228, v220
    v_rcp_f32 v229, v221
    v_rcp_f32 v230, v222
    v_rcp_f32 v231, v223
    v_rcp_f32 v232, v224
    v_rcp_f32 v233, v225
    v_rcp_f32 v234, v226
    v_rcp_f32 v235, v227
    v_min_f32 v220, 0x7f000000, v220
    v_min_f32 v221, 0x7f000000, v221
    v_min_f32 v222, 0x7f000000, v222
    v_min_f32 v223, 0x7f000000, v223
    v_min_f32 v224, 0x7f000000, v224
    v_min_f32 v225, 0x7f000000, v225
    v_min_f32 v226, 0x7f000000, v226
    v_min_f32 v227, 0x7f000000, v227
    v_mul_f32 v236, v196, v228
    v_fma_f32 v220, -v236, v220, v196
    v_fma_f32 v196, v220, v228, v236
    v_mul_f32 v236, v197, v229
    v_fma_f32 v221, -v236, v221, v197
    v_fma_f32 v197, v221, v229, v236
    v_mul_f32 v236, v198, v230
    v_fma_f32 v222, -v236, v222, v198
    v_fma_f32 v198, v222, v230, v236
    v_mul_f32 v236, v199, v231
    v_fma_f32 v223, -v236, v223, v199
    v_fma_f32 v199, v223, v231, v236
    v_mul_f32 v236, v200, v232
    v_fma_f32 v224, -v236, v224, v200
    v_fma_f32 v200, v224, v232, v236
    v_mul_f32 v236, v201, v233
    v_fma_f32 v225, -v236, v225, v201
    v_fma_f32 v201, v225, v233, v236
    v_mul_f32 v236, v202, v234
    v_fma_f32 v226, -v236, v226, v202
    v_fma_f32 v202, v226, v234, v236
    v_mul_f32 v236, v203, v235
    v_fma_f32 v227, -v236, v227, v203
    v_fma_f32 v203, v227, v235, v236
    v_cvt_pk_bf16_f32 v24, v196, v197
    v_cvt_pk_bf16_f32 v25, v198, v199
    v_cvt_pk_bf16_f32 v26, v200, v201
    v_cvt_pk_bf16_f32 v27, v202, v203
    s_cmp_lg_u32 s51, 0
    s_cbranch_scc1 L_Q
L_M:
    v_and_b32 v8, 7, v0
    v_bfe_u32 v9, v0, 3, 1
    v_lshl_add_u32 v8, v8, 1, v9
    v_lshrrev_b32 v9, 4, v0
    v_lshlrev_b32 v7, 6, v8
    v_lshl_add_u32 v7, v9, 4, v7
    s_and_b32 s59, s62, 7
    s_lshl_b32 s59, s59, 10
    s_lshr_b32 s60, s62, 3
    s_lshl_b32 s61, s60, 17
    s_add_u32 s59, s59, s61
    s_add_u32 s59, s59, 0x20000
    v_add_u32 v7, s59, v7
    s_cmp_eq_u32 s60, 1
    s_cselect_b32 s64, 1.0, 0
    s_cmp_eq_u32 s60, 4
    s_cselect_b32 s64, 1.0, s64
    v_mov_b64 v[12:13], v[24:25]
    v_mov_b64 v[16:17], v[26:27]
    s_mul_i32 s59, s3, 0x2100
    buffer_load_dwordx4 v[204:207], v7, s[8:11], s59 offen
L_pad_2:
    s_cbranch_execz L_pad_6
    s_waitcnt vmcnt(15)
    v_perm_b32 v100, v40, v36, s56
    v_perm_b32 v104, v40, v36, s57
    v_perm_b32 v108, v41, v37, s56
    v_perm_b32 v112, v41, v37, s57
    v_perm_b32 v116, v42, v38, s56
    v_perm_b32 v120, v42, v38, s57
    v_perm_b32 v124, v43, v39, s56
    v_perm_b32 v128, v43, v39, s57
    s_waitcnt vmcnt(13)
    v_perm_b32 v101, v48, v44, s56
    v_perm_b32 v105, v48, v44, s57
    v_perm_b32 v109, v49, v45, s56
    v_perm_b32 v113, v49, v45, s57
    v_perm_b32 v117, v50, v46, s56
    v_perm_b32 v121, v50, v46, s57
    v_perm_b32 v125, v51, v47, s56
    v_perm_b32 v129, v51, v47, s57
    s_waitcnt vmcnt(11)
    v_perm_b32 v102, v56, v52, s56
    v_perm_b32 v106, v56, v52, s57
    v_perm_b32 v110, v57, v53, s56
    v_perm_b32 v114, v57, v53, s57
    v_perm_b32 v118, v58, v54, s56
    v_perm_b32 v122, v58, v54, s57
    v_perm_b32 v126, v59, v55, s56
    v_perm_b32 v130, v59, v55, s57
    s_waitcnt vmcnt(9)
    v_perm_b32 v103, v64, v60, s56
    v_perm_b32 v107, v64, v60, s57
    v_perm_b32 v111, v65, v61, s56
    v_perm_b32 v115, v65, v61, s57
    v_perm_b32 v119, v66, v62, s56
    v_perm_b32 v123, v66, v62, s57
    v_perm_b32 v127, v67, v63, s56
    v_perm_b32 v131, v67, v63, s57
    s_waitcnt vmcnt(7)
    v_perm_b32 v132, v72, v68, s56
    v_perm_b32 v136, v72, v68, s57
    v_perm_b32 v140, v73, v69, s56
    v_perm_b32 v144, v73, v69, s57
    v_perm_b32 v148, v74, v70, s56
    v_perm_b32 v152, v74, v70, s57
    v_perm_b32 v156, v75, v71, s56
    v_perm_b32 v160, v75, v71, s57
    s_waitcnt vmcnt(5)
    v_perm_b32 v133, v80, v76, s56
    v_perm_b32 v137, v80, v76, s57
    v_perm_b32 v141, v81, v77, s56
    v_perm_b32 v145, v81, v77, s57
    v_perm_b32 v149, v82, v78, s56
    v_perm_b32 v153, v82, v78, s57
    v_perm_b32 v157, v83, v79, s56
    v_perm_b32 v161, v83, v79, s57
    s_waitcnt vmcnt(3)
    v_perm_b32 v134, v88, v84, s56
    v_perm_b32 v138, v88, v84, s57
    v_perm_b32 v142, v89, v85, s56
    v_perm_b32 v146, v89, v85, s57
    v_perm_b32 v150, v90, v86, s56
    v_perm_b32 v154, v90, v86, s57
    v_perm_b32 v158, v91, v87, s56
    v_perm_b32 v162, v91, v87, s57
    s_waitcnt vmcnt(1)
    v_perm_b32 v135, v96, v92, s56
    v_perm_b32 v139, v96, v92, s57
    v_perm_b32 v143, v97, v93, s56
    v_perm_b32 v147, v97, v93, s57
    v_perm_b32 v151, v98, v94, s56
    v_perm_b32 v155, v98, v94, s57
    v_perm_b32 v159, v99, v95, s56
    v_perm_b32 v163, v99, v95, s57
    s_branch L_S_mm
L_Q:
    v_and_b32 v8, 7, v0
    v_bfe_u32 v9, v0, 3, 1
    v_lshl_add_u32 v8, v8, 1, v9
    v_lshrrev_b32 v9, 4, v0
    v_lshlrev_b32 v7, 4, v8
    v_lshl_add_u32 v7, v9, 11, v7
    s_and_b32 s59, s62, 7
    s_lshl_b32 s59, s59, 8
    s_lshl_b32 s60, s5, 13
    s_add_u32 s59, s59, s60
    s_add_u32 s59, s59, 0xf0000
    v_add_u32 v7, s59, v7
    s_waitcnt vmcnt(16)
    v_lshlrev_b32 v164, 16, v28
    v_and_b32 v165, 0xffff0000, v28
    v_lshlrev_b32 v166, 16, v29
    v_and_b32 v167, 0xffff0000, v29
    v_lshlrev_b32 v168, 16, v30
    v_and_b32 v169, 0xffff0000, v30
    v_lshlrev_b32 v170, 16, v31
    v_and_b32 v171, 0xffff0000, v31
    v_pk_add_f32 v[220:221], v[164:165], v[166:167]
    v_pk_add_f32 v[222:223], v[168:169], v[170:171]
    v_pk_add_f32 v[220:221], v[220:221], v[222:223]
    v_add_f32 v220, v220, v221
    s_nop 1
    v_add_f32_dpp v220, v220, v220 row_ror:8 row_mask:0xf bank_mask:0xf
    s_nop 1
    v_add_f32_dpp v220, v220, v220 row_ror:4 row_mask:0xf bank_mask:0xf
    s_nop 1
    v_add_f32_dpp v220, v220, v220 row_ror:2 row_mask:0xf bank_mask:0xf
    s_nop 1
    v_add_f32_dpp v220, v220, v220 row_ror:1 row_mask:0xf bank_mask:0xf
    v_mov_b32 v221, v220
    s_nop 1
    v_permlane16_swap_b32 v220, v221
    v_add_f32 v220, v220, v221
    v_mov_b32 v221, v220
    s_nop 1
    v_permlane32_swap_b32 v220, v221
    v_add_f32 v220, v220, v221
    v_mul_f32 v220, 0x3b000000, v220
    v_sub_f32 v164, v164, v220
    v_sub_f32 v165, v165, v220
    v_sub_f32 v166, v166, v220
    v_sub_f32 v167, v167, v220
    v_sub_f32 v168, v168, v220
    v_sub_f32 v169, v169, v220
    v_sub_f32 v170, v170, v220
    v_sub_f32 v171, v171, v220
    v_pk_mul_f32 v[222:223], v[164:165], v[164:165]
    v_pk_fma_f32 v[222:223], v[166:167], v[166:167], v[222:223]
L_pad_3:
    s_cbranch_execz L_pad_7
    v_pk_fma_f32 v[222:223], v[168:169], v[168:169], v[222:223]
    v_pk_fma_f32 v[222:223], v[170:171], v[170:171], v[222:223]
    v_add_f32 v221, v222, v223
    s_nop 1
    v_add_f32_dpp v221, v221, v221 row_ror:8 row_mask:0xf bank_mask:0xf
    s_nop 1
    v_add_f32_dpp v221, v221, v221 row_ror:4 row_mask:0xf bank_mask:0xf
    s_nop 1
    v_add_f32_dpp v221, v221, v221 row_ror:2 row_mask:0xf bank_mask:0xf
    s_nop 1
    v_add_f32_dpp v221, v221, v221 row_ror:1 row_mask:0xf bank_mask:0xf
    v_mov_b32 v222, v221
    s_nop 1
    v_permlane16_swap_b32 v221, v222
    v_add_f32 v221, v221, v222
    v_mov_b32 v222, v221
    s_nop 1
    v_permlane32_swap_b32 v221, v222
    v_add_f32 v221, v221, v222
    v_mul_f32 v221, 0x3b000000, v221
    v_cvt_pk_bf16_f32 v222, v220, v221
    v_lshlrev_b32 v220, 16, v222
    v_and_b32 v221, 0xffff0000, v222
    v_add_f32 v221, 0x3727c5ac, v221
    v_cvt_pk_bf16_f32 v221, v221, v221
    v_lshlrev_b32 v221, 16, v221
    v_sqrt_f32 v221, v221
    s_nop 0
    v_cvt_pk_bf16_f32 v221, v221, v221
    v_lshlrev_b32 v221, 16, v221
    v_rcp_f32 v221, v221
    s_lshl_b32 s60, s3, 3
    v_mov_b32 v8, s60
    v_lshlrev_b32 v9, 3, v2
    ds_write_b64 v8, v[220:221] offset:4096
    s_waitcnt lgkmcnt(0)
    s_barrier
    ds_read_b64 v[220:221], v9 offset:4096
    v_lshlrev_b32 v196, 16, v20
    v_and_b32 v197, 0xffff0000, v20
    v_lshlrev_b32 v198, 16, v21
    v_and_b32 v199, 0xffff0000, v21
    v_lshlrev_b32 v200, 16, v22
    v_and_b32 v201, 0xffff0000, v22
    v_lshlrev_b32 v202, 16, v23
    v_and_b32 v203, 0xffff0000, v23
    s_waitcnt lgkmcnt(0)
    v_sub_f32 v196, v196, v220
    v_sub_f32 v197, v197, v220
    v_sub_f32 v198, v198, v220
    v_sub_f32 v199, v199, v220
    v_sub_f32 v200, v200, v220
    v_sub_f32 v201, v201, v220
    v_sub_f32 v202, v202, v220
    v_sub_f32 v203, v203, v220
    v_cvt_pk_bf16_f32 v222, v196, v197
    v_lshlrev_b32 v196, 16, v222
    v_and_b32 v197, 0xffff0000, v222
    v_cvt_pk_bf16_f32 v222, v198, v199
    v_lshlrev_b32 v198, 16, v222
    v_and_b32 v199, 0xffff0000, v222
    v_cvt_pk_bf16_f32 v222, v200, v201
    v_lshlrev_b32 v200, 16, v222
    v_and_b32 v201, 0xffff0000, v222
    v_cvt_pk_bf16_f32 v222, v202, v203
    v_lshlrev_b32 v202, 16, v222
    v_and_b32 v203, 0xffff0000, v222
    v_mul_f32 v196, v196, v221
    v_mul_f32 v197, v197, v221
    v_mul_f32 v198, v198, v221
    v_mul_f32 v199, v199, v221
    v_mul_f32 v200, v200, v221
    v_mul_f32 v201, v201, v221
    v_mul_f32 v202, v202, v221
    v_mul_f32 v203, v203, v221
    v_cvt_pk_bf16_f32 v222, v196, v197
    v_lshlrev_b32 v196, 16, v222
    v_and_b32 v197, 0xffff0000, v222
    v_cvt_pk_bf16_f32 v222, v198, v199
    v_lshlrev_b32 v198, 16, v222
    v_and_b32 v199, 0xffff0000, v222
    v_cvt_pk_bf16_f32 v222, v200, v201
    v_lshlrev_b32 v200, 16, v222
    v_and_b32 v201, 0xffff0000, v222
    v_cvt_pk_bf16_f32 v222, v202, v203
    v_lshlrev_b32 v202, 16, v222
    v_and_b32 v203, 0xffff0000, v222
    s_waitcnt vmcnt(14)
    v_perm_b32 v100, v40, v36, s56
    v_perm_b32 v104, v40, v36, s57
    v_perm_b32 v108, v41, v37, s56
    v_perm_b32 v112, v41, v37, s57
    v_perm_b32 v116, v42, v38, s56
    v_perm_b32 v120, v42, v38, s57
    v_perm_b32 v124, v43, v39, s56
    v_perm_b32 v128, v43, v39, s57
    s_waitcnt vmcnt(12)
    v_perm_b32 v101, v48, v44, s56
    v_perm_b32 v105, v48, v44, s57
    v_perm_b32 v109, v49, v45, s56
    v_perm_b32 v113, v49, v45, s57
    v_perm_b32 v117, v50, v46, s56
    v_perm_b32 v121, v50, v46, s57
    v_perm_b32 v125, v51, v47, s56
    v_perm_b32 v129, v51, v47, s57
    s_waitcnt vmcnt(10)
    v_perm_b32 v102, v56, v52, s56
    v_perm_b32 v106, v56, v52, s57
    v_perm_b32 v110, v57, v53, s56
    v_perm_b32 v114, v57, v53, s57
    v_perm_b32 v118, v58, v54, s56
    v_perm_b32 v122, v58, v54, s57
    v_perm_b32 v126, v59, v55, s56
    v_perm_b32 v130, v59, v55, s57
    s_waitcnt vmcnt(8)
    v_perm_b32 v103, v64, v60, s56
    v_perm_b32 v107, v64, v60, s57
    v_perm_b32 v111, v65, v61, s56
    v_perm_b32 v115, v65, v61, s57
    v_perm_b32 v119, v66, v62, s56
    v_perm_b32 v123, v66, v62, s57
    v_perm_b32 v127, v67, v63, s56
    v_perm_b32 v131, v67, v63, s57
    s_waitcnt vmcnt(6)
    v_perm_b32 v132, v72, v68, s56
    v_perm_b32 v136, v72, v68, s57
    v_perm_b32 v140, v73, v69, s56
    v_perm_b32 v144, v73, v69, s57
    v_perm_b32 v148, v74, v70, s56
    v_perm_b32 v152, v74, v70, s57
    v_perm_b32 v156, v75, v71, s56
    v_perm_b32 v160, v75, v71, s57
    s_waitcnt vmcnt(4)
    v_perm_b32 v133, v80, v76, s56
    v_perm_b32 v137, v80, v76, s57
    v_perm_b32 v141, v81, v77, s56
    v_perm_b32 v145, v81, v77, s57
    v_perm_b32 v149, v82, v78, s56
    v_perm_b32 v153, v82, v78, s57
    v_perm_b32 v157, v83, v79, s56
    v_perm_b32 v161, v83, v79, s57
    s_waitcnt vmcnt(2)
    v_perm_b32 v134, v88, v84, s56
    v_perm_b32 v138, v88, v84, s57
    v_perm_b32 v142, v89, v85, s56
    v_perm_b32 v146, v89, v85, s57
    v_perm_b32 v150, v90, v86, s56
    v_perm_b32 v154, v90, v86, s57
    v_perm_b32 v158, v91, v87, s56
    v_perm_b32 v162, v91, v87, s57
    s_waitcnt vmcnt(0)
    v_perm_b32 v135, v96, v92, s56
    v_perm_b32 v139, v96, v92, s57
    v_perm_b32 v143, v97, v93, s56
    v_perm_b32 v147, v97, v93, s57
    v_perm_b32 v151, v98, v94, s56
    v_perm_b32 v155, v98, v94, s57
    v_perm_b32 v159, v99, v95, s56
    v_perm_b32 v163, v99, v95, s57
    s_cmp_lg_u32 s3, 0
    s_cbranch_scc1 L_gate_1
    s_mov_b32 exec_lo, 0x1111
    s_mov_b32 exec_hi, 0x0
L_poll_2:
    buffer_load_dwordx4 v[204:207], v11, s[8:11], 0 offen offset:0 sc1
    s_sub_u32 s58, s58, 1
    s_cbranch_scc1 L_end
L_chk_3:
    s_waitcnt vmcnt(0)
L_chk_3_w:
    v_cmp_ne_u32 vcc, v207, v5
    s_cbranch_vccnz L_poll_2
    s_mov_b64 exec, -1
L_gate_1:
L_pad_4:
    s_cbranch_execz L_pad_8
    s_barrier
L_poll_4:
    buffer_load_dwordx4 v[204:207], v11, s[8:11], 0 offen offset:0 sc1
    buffer_load_dwordx4 v[208:211], v10, s[8:11], 0 offen offset:0 sc1
    buffer_load_dwordx4 v[212:215], v11, s[8:11], 0 offen offset:1024 sc1
    buffer_load_dwordx4 v[216:219], v10, s[8:11], 0 offen offset:1024 sc1
    s_sub_u32 s58, s58, 1
    s_cbranch_scc1 L_end
L_chk_5:
    s_waitcnt vmcnt(0)
L_chk_5_w:
    v_min3_u32 v8, v207, v211, v215
    v_max3_u32 v9, v207, v211, v215
    v_min_u32 v8, v8, v219
    v_max_u32 v9, v9, v219
    v_cmp_ne_u32 vcc, v8, v5
    v_cmp_ne_u32 s[70:71], v9, v5
    s_or_b64 vcc, vcc, s[70:71]
    s_cbranch_vccnz L_poll_4
    v_lshlrev_b32 v220, 16, v204
    v_and_b32 v221, 0xffff0000, v204
    v_lshlrev_b32 v222, 16, v205
    v_and_b32 v223, 0xffff0000, v205
    v_pk_mul_f32 v[220:221], v[220:221], v[196:197]
    v_pk_mul_f32 v[222:223], v[222:223], v[198:199]
    v_lshlrev_b32 v224, 16, v208
    v_and_b32 v225, 0xffff0000, v208
    v_lshlrev_b32 v226, 16, v209
    v_and_b32 v227, 0xffff0000, v209
    v_cvt_pk_bf16_f32 v228, v220, v221
    v_lshlrev_b32 v220, 16, v228
    v_and_b32 v221, 0xffff0000, v228
    v_cvt_pk_bf16_f32 v229, v222, v223
    v_lshlrev_b32 v222, 16, v229
    v_and_b32 v223, 0xffff0000, v229
    v_pk_add_f32 v[220:221], v[220:221], v[224:225]
    v_pk_add_f32 v[222:223], v[222:223], v[226:227]
    v_cvt_pk_bf16_f32 v12, v220, v221
    v_cvt_pk_bf16_f32 v13, v222, v223
    v_lshlrev_b32 v230, 16, v212
    v_and_b32 v231, 0xffff0000, v212
    v_lshlrev_b32 v232, 16, v213
    v_and_b32 v233, 0xffff0000, v213
    v_pk_mul_f32 v[230:231], v[230:231], v[200:201]
    v_pk_mul_f32 v[232:233], v[232:233], v[202:203]
    v_lshlrev_b32 v234, 16, v216
    v_and_b32 v235, 0xffff0000, v216
    v_lshlrev_b32 v236, 16, v217
    v_and_b32 v237, 0xffff0000, v217
    v_cvt_pk_bf16_f32 v238, v230, v231
    v_lshlrev_b32 v230, 16, v238
    v_and_b32 v231, 0xffff0000, v238
    v_cvt_pk_bf16_f32 v239, v232, v233
    v_lshlrev_b32 v232, 16, v239
    v_and_b32 v233, 0xffff0000, v239
    v_pk_add_f32 v[230:231], v[230:231], v[234:235]
    v_pk_add_f32 v[232:233], v[232:233], v[236:237]
    v_cvt_pk_bf16_f32 v16, v230, v231
    v_cvt_pk_bf16_f32 v17, v232, v233
L_S_mm:
    v_mov_b32_dpp v14, v12 quad_perm:[2,3,2,3] row_mask:0xf bank_mask:0xf
    v_mov_b32_dpp v15, v13 quad_perm:[2,3,2,3] row_mask:0xf bank_mask:0xf
    v_mov_b32_dpp v18, v16 quad_perm:[2,3,2,3] row_mask:0xf bank_mask:0xf
    v_mov_b32_dpp v19, v17 quad_perm:[2,3,2,3] row_mask:0xf bank_mask:0xf
    v_mfma_f32_16x16x32_bf16 v[164:167], v[12:15], v[100:103], 0
    v_mfma_f32_16x16x32_bf16 v[180:183], v[12:15], v[116:119], 0
    v_mfma_f32_16x16x32_bf16 v[168:171], v[12:15], v[104:107], 0
    v_mfma_f32_16x16x32_bf16 v[184:187], v[12:15], v[120:123], 0
    v_mfma_f32_16x16x32_bf16 v[172:175], v[12:15], v[108:111], 0
    v_mfma_f32_16x16x32_bf16 v[188:191], v[12:15], v[124:127], 0
    v_mfma_f32_16x16x32_bf16 v[176:179], v[12:15], v[112:115], 0
    v_mfma_f32_16x16x32_bf16 v[192:195], v[12:15], v[128:131], 0
    v_mfma_f32_16x16x32_bf16 v[164:167], v[16:19], v[132:135], v[164:167]
    v_mfma_f32_16x16x32_bf16 v[180:183], v[16:19], v[148:151], v[180:183]
    v_mfma_f32_16x16x32_bf16 v[168:171], v[16:19], v[136:139], v[168:171]
    v_mfma_f32_16x16x32_bf16 v[184:187], v[16:19], v[152:155], v[184:187]
    v_mfma_f32_16x16x32_bf16 v[172:175], v[16:19], v[140:143], v[172:175]
    v_mfma_f32_16x16x32_bf16 v[188:191], v[16:19], v[156:159], v[188:191]
    v_mfma_f32_16x16x32_bf16 v[176:179], v[16:19], v[144:147], v[176:179]
    v_mfma_f32_16x16x32_bf16 v[192:195], v[16:19], v[160:163], v[192:195]
    s_nop 0
    v_add_f32_dpp v220, v165, v164 row_ror:8 row_mask:0xf bank_mask:0x3
    v_add_f32_dpp v220, v180, v181 row_ror:8 row_mask:0xf bank_mask:0xc
    v_add_f32_dpp v221, v169, v168 row_ror:8 row_mask:0xf bank_mask:0x3
    v_add_f32_dpp v221, v184, v185 row_ror:8 row_mask:0xf bank_mask:0xc
    v_add_f32_dpp v222, v173, v172 row_ror:8 row_mask:0xf bank_mask:0x3
    v_add_f32_dpp v222, v188, v189 row_ror:8 row_mask:0xf bank_mask:0xc
    v_add_f32_dpp v223, v177, v176 row_ror:8 row_mask:0xf bank_mask:0x3
    v_add_f32_dpp v223, v192, v193 row_ror:8 row_mask:0xf bank_mask:0xc
    ds_write_b128 v6, v[220:223] offset:0
    v_lshlrev_b32 v8, 4, v0
    v_mov_b32 v226, 0
    v_mov_b32 v227, v5
    s_waitcnt lgkmcnt(0)
    s_barrier
    s_cmp_lg_u32 s3, 0
    s_cbranch_scc1 L_nopub_6
    ds_read_b128 v[228:231], v8 offset:0
    ds_read_b128 v[232:235], v8 offset:1024
    ds_read_b128 v[236:239], v8 offset:2048
    ds_read_b128 v[240:243], v8 offset:3072
    s_movk_i32 s59, 0x2100
    s_movk_i32 s60, 0x4200
    s_movk_i32 s61, 0x6300
    s_waitcnt lgkmcnt(0)
    v_pk_add_f32 v[220:221], v[228:229], v[232:233]
    v_pk_add_f32 v[222:223], v[230:231], v[234:235]
    v_pk_add_f32 v[236:237], v[236:237], v[240:241]
    v_pk_add_f32 v[238:239], v[238:239], v[242:243]
    v_pk_add_f32 v[220:221], v[220:221], v[236:237]
    v_pk_add_f32 v[222:223], v[222:223], v[238:239]
    v_cvt_pk_bf16_f32 v224, v220, v221
    v_cvt_pk_bf16_f32 v225, v222, v223
    s_cmp_lg_u32 s51, 0
    s_cbranch_scc1 L_qpub_7
    v_lshlrev_b32 v220, 16, v224
    v_and_b32 v221, 0xffff0000, v224
    v_lshlrev_b32 v222, 16, v225
    v_and_b32 v223, 0xffff0000, v225
    v_add_f32 v220, s64, v220
    v_add_f32 v221, s64, v221
    v_add_f32 v222, s64, v222
    v_add_f32 v223, s64, v223
    v_cvt_pk_bf16_f32 v224, v220, v221
    v_cvt_pk_bf16_f32 v225, v222, v223
    buffer_store_dwordx4 v[224:227], v7, s[8:11], s59 offen sc1
    buffer_store_dwordx4 v[224:227], v7, s[8:11], s60 offen sc1
    buffer_store_dwordx4 v[224:227], v7, s[8:11], s61 offen sc1
    s_branch L_qpub_7b
L_qpub_7:
    s_mov_b32 s59, 0x280000
    buffer_store_dwordx4 v[224:227], v7, s[8:11], s59 offen
L_qpub_7b:
    buffer_store_dwordx4 v[224:227], v7, s[8:11], 0 offen sc1
L_qpub_7c:
L_nopub_6:
L_S_post:
    s_cmp_lt_u32 s6, 3
    s_cbranch_scc1 L_FFN
    s_cmp_lt_u32 s38, 4
    s_cbranch_scc1 L_FFN
    s_branch L_end
L_FFN:
    s_mul_i32 s7, s5, 7
    s_add_u32 s63, s63, s7
    v_bfe_u32 v8, v0, 3, 1
    v_lshrrev_b32 v9, 4, v0
    v_lshl_add_u32 v8, v8, 2, v9
    s_lshl_b32 s7, s3, 4
    v_add_u32 v8, s7, v8
    v_mul_u32_u24 v8, 28672, v8
    v_and_b32 v10, 3, v0
    v_lshl_add_u32 v8, v10, 4, v8
    s_lshl_b32 s7, s63, 6
    v_add_u32 v8, s7, v8
    v_and_b32 v10, 4, v0
    v_cmp_eq_u32 vcc, 0, v10
    v_mov_b32 v24, s36
    v_mov_b32 v25, s37
    v_mov_b32 v10, s32
    v_mov_b32 v11, s33
    v_cndmask_b32 v24, v24, v10, vcc
    v_cndmask_b32 v25, v25, v11, vcc
    v_add_co_u32 v24, vcc, v24, v8
    s_mov_b32 s42, 0x1c0000
    s_mov_b32 s43, 0x20000
    v_addc_co_u32 v25, vcc, 0, v25, vcc
    v_and_b32 v8, 15, v0
    v_lshlrev_b32 v10, 13, v9
    v_lshl_add_u32 v10, v8, 4, v10
    s_lshl_b32 s59, s63, 15
    s_lshl_b32 s60, s3, 8
    s_add_u32 s59, s59, s60
    s_add_u32 s60, s59, 4096
    s_barrier
    v_add_u32 v26, 0xa0000, v4
    v_add_u32 v27, 0x80000, v4
    global_load_dwordx4 v[36:39], v[24:25], off
    global_load_dwordx4 v[40:43], v[24:25], off offset:3584
    v_add_co_u32 v24, vcc, 7168, v24
    s_nop 1
    v_addc_co_u32 v25, vcc, 0, v25, vcc
L_pad_5:
    s_cbranch_execz L_warm_done
    global_load_dwordx4 v[44:47], v[24:25], off
    global_load_dwordx4 v[48:51], v[24:25], off offset:3584
    v_add_co_u32 v24, vcc, 7168, v24
    s_nop 1
    v_addc_co_u32 v25, vcc, 0, v25, vcc
    global_load_dwordx4 v[52:55], v[24:25], off
    global_load_dwordx4 v[56:59], v[24:25], off offset:3584
    v_add_co_u32 v24, vcc, 7168, v24
    s_nop 1
    v_addc_co_u32 v25, vcc, 0, v25, vcc
    global_load_dwordx4 v[60:63], v[24:25], off
    global_load_dwordx4 v[64:67], v[24:25], off offset:3584
    v_add_co_u32 v24, vcc, 207872, v24
    s_nop 1
    v_addc_co_u32 v25, vcc, 0, v25, vcc
    global_load_dwordx4 v[68:71], v[24:25], off
    global_load_dwordx4 v[72:75], v[24:25], off offset:3584
    v_add_co_u32 v24, vcc, 7168, v24
    s_nop 1
    v_addc_co_u32 v25, vcc, 0, v25, vcc
    global_load_dwordx4 v[76:79], v[24:25], off
    global_load_dwordx4 v[80:83], v[24:25], off offset:3584
    v_add_co_u32 v24, vcc, 7168, v24
    s_nop 1
    v_addc_co_u32 v25, vcc, 0, v25, vcc
    global_load_dwordx4 v[84:87], v[24:25], off
    global_load_dwordx4 v[88:91], v[24:25], off offset:3584
    v_add_co_u32 v24, vcc, 7168, v24
    s_nop 1
    v_addc_co_u32 v25, vcc, 0, v25, vcc
    global_load_dwordx4 v[92:95], v[24:25], off
    global_load_dwordx4 v[96:99], v[24:25], off offset:3584
    v_mov_b32 v34, v26
    v_mov_b32 v35, v27
    buffer_load_dwordx4 v[204:207], v34, s[8:11], 0 offen offset:0 sc1
    buffer_load_dwordx4 v[208:211], v34, s[8:11], 0 offen offset:1024 sc1
    buffer_load_dwordx4 v[212:215], v35, s[8:11], 0 offen offset:0 sc1
    buffer_load_dwordx4 v[216:219], v35, s[8:11], 0 offen offset:1024 sc1
    buffer_load_dwordx4 a[0:3], v10, s[40:43], s59 offen offset:0 nt
    buffer_load_dwordx4 a[4:7], v10, s[40:43], s59 offen offset:1024 nt
    buffer_load_dwordx4 a[8:11], v10, s[40:43], s59 offen offset:2048 nt
    buffer_load_dwordx4 a[12:15], v10, s[40:43], s59 offen offset:3072 nt
    buffer_load_dwordx4 a[16:19], v10, s[40:43], s60 offen offset:0 nt
    buffer_load_dwordx4 a[20:23], v10, s[40:43], s60 offen offset:1024 nt
    buffer_load_dwordx4 a[24:27], v10, s[40:43], s60 offen offset:2048 nt
    buffer_load_dwordx4 a[28:31], v10, s[40:43], s60 offen offset:3072 nt
    v_add_lshl_u32 v4, v1, v2, 4
    s_mul_i32 s7, s5, 0x2100
    s_add_u32 s7, s7, 0x3c0000
    v_add_u32 v4, s7, v4
    v_lshrrev_b32 v3, 5, v0
    v_lshlrev_b32 v3, 2, v3
    v_lshl_add_u32 v3, v2, 5, v3
    s_lshl_b32 s7, s3, 3
    v_add_u32 v3, s7, v3
    s_lshl_b32 s7, s3, 5
    v_mov_b32 v10, s7
    v_lshlrev_b32 v7, 10, v9
    v_lshl_add_u32 v7, v8, 4, v7
    s_lshl_b32 s7, s3, 8
    v_add_u32 v7, s7, v7
    v_and_b32 v11, 3, v0
    v_lshl_add_u32 v11, v11, 3, v9
    v_bfe_u32 v26, v0, 3, 1
    v_lshl_add_u32 v11, v26, 2, v11
    v_lshlrev_b32 v11, 1, v11
    s_lshl_b32 s7, s3, 6
    v_add_u32 v11, s7, v11
    v_lshlrev_b32 v26, 6, v2
    v_lshl_add_u32 v26, v9, 4, v26
    s_lshl_b32 s7, s3, 4
    v_and_b32 v27, 14, v8
    v_add_u32 v27, s7, v27
    v_mul_u32_u24 v27, 7168, v27
    v_lshl_add_u32 v27, v9, 4, v27
    v_and_b32 v8, 1, v8
    v_lshl_add_u32 v27, v8, 6, v27
    s_lshl_b32 s62, s63, 7
    s_add_u32 s62, s62, 0x290000
    s_add_u32 s61, s62, 7168
    s_mov_b32 s20, 0x07060501
    s_mov_b32 s21, 0x07060502
    s_mov_b32 s22, 0x07060503
    s_mov_b32 s66, 0x33333333
    s_mov_b32 s67, 0x33333333
    buffer_load_dwordx4 a[32:35], v27, s[8:11], s62 offen
    buffer_load_dwordx4 a[36:39], v27, s[8:11], s61 offen
    s_waitcnt vmcnt(28)
    v_perm_b32 v100, v40, v36, s56
    v_perm_b32 v104, v40, v36, s57
    v_perm_b32 v108, v41, v37, s56
    v_perm_b32 v112, v41, v37, s57
    v_perm_b32 v116, v42, v38, s56
    v_perm_b32 v120, v42, v38, s57
    v_perm_b32 v124, v43, v39, s56
    v_perm_b32 v128, v43, v39, s57
    s_waitcnt vmcnt(26)
    v_perm_b32 v101, v48, v44, s56
    v_perm_b32 v105, v48, v44, s57
    v_perm_b32 v109, v49, v45, s56
    v_perm_b32 v113, v49, v45, s57
    v_perm_b32 v117, v50, v46, s56
    v_perm_b32 v121, v50, v46, s57
    v_perm_b32 v125, v51, v47, s56
    v_perm_b32 v129, v51, v47, s57
    s_waitcnt vmcnt(24)
    v_perm_b32 v102, v56, v52, s56
    v_perm_b32 v106, v56, v52, s57
    v_perm_b32 v110, v57, v53, s56
    v_perm_b32 v114, v57, v53, s57
    v_perm_b32 v118, v58, v54, s56
    v_perm_b32 v122, v58, v54, s57
    v_perm_b32 v126, v59, v55, s56
    v_perm_b32 v130, v59, v55, s57
    s_waitcnt vmcnt(22)
    v_perm_b32 v103, v64, v60, s56
    v_perm_b32 v107, v64, v60, s57
    v_perm_b32 v111, v65, v61, s56
    v_perm_b32 v115, v65, v61, s57
    v_perm_b32 v119, v66, v62, s56
    v_perm_b32 v123, v66, v62, s57
    v_perm_b32 v127, v67, v63, s56
    v_perm_b32 v131, v67, v63, s57
    s_waitcnt vmcnt(20)
    v_perm_b32 v132, v72, v68, s56
    v_perm_b32 v136, v72, v68, s57
    v_perm_b32 v140, v73, v69, s56
    v_perm_b32 v144, v73, v69, s57
    v_perm_b32 v148, v74, v70, s56
    v_perm_b32 v152, v74, v70, s57
    v_perm_b32 v156, v75, v71, s56
    v_perm_b32 v160, v75, v71, s57
    s_waitcnt vmcnt(18)
    v_perm_b32 v133, v80, v76, s56
    v_perm_b32 v137, v80, v76, s57
    v_perm_b32 v141, v81, v77, s56
    v_perm_b32 v145, v81, v77, s57
    v_perm_b32 v149, v82, v78, s56
    v_perm_b32 v153, v82, v78, s57
    v_perm_b32 v157, v83, v79, s56
    v_perm_b32 v161, v83, v79, s57
    s_waitcnt vmcnt(16)
    v_perm_b32 v134, v88, v84, s56
    v_perm_b32 v138, v88, v84, s57
    v_perm_b32 v142, v89, v85, s56
    v_perm_b32 v146, v89, v85, s57
    v_perm_b32 v150, v90, v86, s56
    v_perm_b32 v154, v90, v86, s57
    v_perm_b32 v158, v91, v87, s56
    v_perm_b32 v162, v91, v87, s57
    s_waitcnt vmcnt(14)
    v_perm_b32 v135, v96, v92, s56
    v_perm_b32 v139, v96, v92, s57
    v_perm_b32 v143, v97, v93, s56
    v_perm_b32 v147, v97, v93, s57
    v_perm_b32 v151, v98, v94, s56
    v_perm_b32 v155, v98, v94, s57
L_pad_6:
    s_cbranch_execz L_warm_done
    v_perm_b32 v159, v99, v95, s56
    v_perm_b32 v163, v99, v95, s57
    s_waitcnt vmcnt(10)
    s_branch L_chk_9_w
L_poll_8:
    buffer_load_dwordx4 v[204:207], v34, s[8:11], 0 offen offset:0 sc1
    buffer_load_dwordx4 v[208:211], v34, s[8:11], 0 offen offset:1024 sc1
    buffer_load_dwordx4 v[212:215], v35, s[8:11], 0 offen offset:0 sc1
    buffer_load_dwordx4 v[216:219], v35, s[8:11], 0 offen offset:1024 sc1
    s_sub_u32 s58, s58, 1
    s_cbranch_scc1 L_end
L_chk_9:
    s_waitcnt vmcnt(0)
L_chk_9_w:
    v_min3_u32 v8, v207, v211, v215
    v_max3_u32 v9, v207, v211, v215
    v_min_u32 v8, v8, v219
    v_max_u32 v9, v9, v219
    v_cmp_ne_u32 vcc, v8, v5
    v_cmp_ne_u32 s[70:71], v9, v5
    s_or_b64 vcc, vcc, s[70:71]
    s_cbranch_vccnz L_poll_8
    v_lshlrev_b32 v196, 16, v204
    v_and_b32 v197, 0xffff0000, v204
    v_lshlrev_b32 v198, 16, v205
    v_and_b32 v199, 0xffff0000, v205
    v_lshlrev_b32 v200, 16, v208
    v_and_b32 v201, 0xffff0000, v208
    v_lshlrev_b32 v202, 16, v209
    v_and_b32 v203, 0xffff0000, v209
    v_mov_b32_dpp v206, v204 quad_perm:[2,3,2,3] row_mask:0xf bank_mask:0xf
    v_mov_b32_dpp v207, v205 quad_perm:[2,3,2,3] row_mask:0xf bank_mask:0xf
    v_mov_b32_dpp v210, v208 quad_perm:[2,3,2,3] row_mask:0xf bank_mask:0xf
    v_mov_b32_dpp v211, v209 quad_perm:[2,3,2,3] row_mask:0xf bank_mask:0xf
    v_mfma_f32_16x16x32_bf16 v[164:167], v[204:207], v[100:103], 0
    v_mfma_f32_16x16x32_bf16 v[180:183], v[204:207], v[116:119], 0
    v_mfma_f32_16x16x32_bf16 v[168:171], v[204:207], v[104:107], 0
    v_mfma_f32_16x16x32_bf16 v[184:187], v[204:207], v[120:123], 0
    v_mfma_f32_16x16x32_bf16 v[172:175], v[204:207], v[108:111], 0
    v_mfma_f32_16x16x32_bf16 v[188:191], v[204:207], v[124:127], 0
    v_mfma_f32_16x16x32_bf16 v[176:179], v[204:207], v[112:115], 0
    v_mfma_f32_16x16x32_bf16 v[192:195], v[204:207], v[128:131], 0
    v_mfma_f32_16x16x32_bf16 v[164:167], v[208:211], v[132:135], v[164:167]
    v_mfma_f32_16x16x32_bf16 v[180:183], v[208:211], v[148:151], v[180:183]
    v_mfma_f32_16x16x32_bf16 v[168:171], v[208:211], v[136:139], v[168:171]
    v_mfma_f32_16x16x32_bf16 v[184:187], v[208:211], v[152:155], v[184:187]
    v_mfma_f32_16x16x32_bf16 v[172:175], v[208:211], v[140:143], v[172:175]
    v_mfma_f32_16x16x32_bf16 v[188:191], v[208:211], v[156:159], v[188:191]
    v_mfma_f32_16x16x32_bf16 v[176:179], v[208:211], v[144:147], v[176:179]
    v_mfma_f32_16x16x32_bf16 v[192:195], v[208:211], v[160:163], v[192:195]
    s_nop 0
    v_add_f32_dpp v220, v165, v164 row_ror:8 row_mask:0xf bank_mask:0x3
    v_add_f32_dpp v220, v180, v181 row_ror:8 row_mask:0xf bank_mask:0xc
    v_add_f32_dpp v221, v169, v168 row_ror:8 row_mask:0xf bank_mask:0x3
    v_add_f32_dpp v221, v184, v185 row_ror:8 row_mask:0xf bank_mask:0xc
    v_add_f32_dpp v222, v173, v172 row_ror:8 row_mask:0xf bank_mask:0x3
    v_add_f32_dpp v222, v188, v189 row_ror:8 row_mask:0xf bank_mask:0xc
    v_add_f32_dpp v223, v177, v176 row_ror:8 row_mask:0xf bank_mask:0x3
    v_add_f32_dpp v223, v192, v193 row_ror:8 row_mask:0xf bank_mask:0xc
    ds_write_b128 v6, v[220:223] offset:4288
    v_mov_b32_dpp v214, v212 quad_perm:[2,3,2,3] row_mask:0xf bank_mask:0xf
    v_mov_b32_dpp v215, v213 quad_perm:[2,3,2,3] row_mask:0xf bank_mask:0xf
    v_mov_b32_dpp v218, v216 quad_perm:[2,3,2,3] row_mask:0xf bank_mask:0xf
    v_mov_b32_dpp v219, v217 quad_perm:[2,3,2,3] row_mask:0xf bank_mask:0xf
    v_mfma_f32_16x16x32_bf16 v[164:167], v[212:215], v[100:103], 0
    v_mfma_f32_16x16x32_bf16 v[180:183], v[212:215], v[116:119], 0
    v_mfma_f32_16x16x32_bf16 v[168:171], v[212:215], v[104:107], 0
    v_mfma_f32_16x16x32_bf16 v[184:187], v[212:215], v[120:123], 0
    v_mfma_f32_16x16x32_bf16 v[172:175], v[212:215], v[108:111], 0
    v_mfma_f32_16x16x32_bf16 v[188:191], v[212:215], v[124:127], 0
    v_mfma_f32_16x16x32_bf16 v[176:179], v[212:215], v[112:115], 0
    v_mfma_f32_16x16x32_bf16 v[192:195], v[212:215], v[128:131], 0
    v_mfma_f32_16x16x32_bf16 v[164:167], v[216:219], v[132:135], v[164:167]
    v_mfma_f32_16x16x32_bf16 v[180:183], v[216:219], v[148:151], v[180:183]
    v_mfma_f32_16x16x32_bf16 v[168:171], v[216:219], v[136:139], v[168:171]
    v_mfma_f32_16x16x32_bf16 v[184:187], v[216:219], v[152:155], v[184:187]
    v_mfma_f32_16x16x32_bf16 v[172:175], v[216:219], v[140:143], v[172:175]
    v_mfma_f32_16x16x32_bf16 v[188:191], v[216:219], v[156:159], v[188:191]
    v_mfma_f32_16x16x32_bf16 v[176:179], v[216:219], v[144:147], v[176:179]
    v_mfma_f32_16x16x32_bf16 v[192:195], v[216:219], v[160:163], v[192:195]
    s_nop 0
    v_add_f32_dpp v220, v165, v164 row_ror:8 row_mask:0xf bank_mask:0x3
    v_add_f32_dpp v220, v180, v181 row_ror:8 row_mask:0xf bank_mask:0xc
    v_add_f32_dpp v221, v169, v168 row_ror:8 row_mask:0xf bank_mask:0x3
    v_add_f32_dpp v221, v184, v185 row_ror:8 row_mask:0xf bank_mask:0xc
    v_add_f32_dpp v222, v173, v172 row_ror:8 row_mask:0xf bank_mask:0x3
    v_add_f32_dpp v222, v188, v189 row_ror:8 row_mask:0xf bank_mask:0xc
    v_add_f32_dpp v223, v177, v176 row_ror:8 row_mask:0xf bank_mask:0x3
    v_add_f32_dpp v223, v192, v193 row_ror:8 row_mask:0xf bank_mask:0xc
    ds_write_b128 v6, v[220:223] offset:8384
    s_waitcnt lgkmcnt(0)
    s_barrier
    ds_read_b128 v[220:223], v7 offset:4288
    ds_read_b128 v[224:227], v7 offset:8384
    s_waitcnt lgkmcnt(0)
    v_permlane32_swap_b32 v220, v222
    v_permlane32_swap_b32 v221, v223
    v_add_f32 v220, v220, v222
    v_add_f32 v221, v221, v223
    s_nop 1
    v_permlane16_swap_b32 v220, v221
    v_add_f32 v32, v220, v221
    v_permlane32_swap_b32 v224, v226
    v_permlane32_swap_b32 v225, v227
    v_add_f32 v224, v224, v226
    v_add_f32 v225, v225, v227
    s_nop 1
    v_permlane16_swap_b32 v224, v225
    v_add_f32 v33, v224, v225
    s_waitcnt vmcnt(0)
    v_accvgpr_read_b32 v164, a0
    v_accvgpr_read_b32 v165, a1
    v_accvgpr_read_b32 v166, a2
    v_accvgpr_read_b32 v167, a3
    v_accvgpr_read_b32 v168, a4
    v_accvgpr_read_b32 v169, a5
    v_accvgpr_read_b32 v170, a6
    v_accvgpr_read_b32 v171, a7
    v_accvgpr_read_b32 v172, a8
    v_accvgpr_read_b32 v173, a9
    v_accvgpr_read_b32 v174, a10
    v_accvgpr_read_b32 v175, a11
    v_accvgpr_read_b32 v176, a12
L_pad_7:
    s_cbranch_execz L_warm_done
    v_accvgpr_read_b32 v177, a13
    v_accvgpr_read_b32 v178, a14
    v_accvgpr_read_b32 v179, a15
    v_accvgpr_read_b32 v180, a16
    v_accvgpr_read_b32 v181, a17
    v_accvgpr_read_b32 v182, a18
    v_accvgpr_read_b32 v183, a19
    v_accvgpr_read_b32 v184, a20
    v_accvgpr_read_b32 v185, a21
    v_accvgpr_read_b32 v186, a22
    v_accvgpr_read_b32 v187, a23
    v_accvgpr_read_b32 v188, a24
    v_accvgpr_read_b32 v189, a25
    v_accvgpr_read_b32 v190, a26
    v_accvgpr_read_b32 v191, a27
    v_accvgpr_read_b32 v192, a28
    v_accvgpr_read_b32 v193, a29
    v_accvgpr_read_b32 v194, a30
    v_accvgpr_read_b32 v195, a31
    v_perm_b32 v36, v168, v164, s56
    v_perm_b32 v40, v168, v164, s57
    v_perm_b32 v44, v169, v165, s56
    v_perm_b32 v48, v169, v165, s57
    v_perm_b32 v52, v170, v166, s56
    v_perm_b32 v56, v170, v166, s57
    v_perm_b32 v60, v171, v167, s56
    v_perm_b32 v64, v171, v167, s57
    v_perm_b32 v37, v176, v172, s56
    v_perm_b32 v41, v176, v172, s57
    v_perm_b32 v45, v177, v173, s56
    v_perm_b32 v49, v177, v173, s57
    v_perm_b32 v53, v178, v174, s56
    v_perm_b32 v57, v178, v174, s57
    v_perm_b32 v61, v179, v175, s56
    v_perm_b32 v65, v179, v175, s57
    v_perm_b32 v38, v184, v180, s56
    v_perm_b32 v42, v184, v180, s57
    v_perm_b32 v46, v185, v181, s56
    v_perm_b32 v50, v185, v181, s57
    v_perm_b32 v54, v186, v182, s56
    v_perm_b32 v58, v186, v182, s57
    v_perm_b32 v62, v187, v183, s56
    v_perm_b32 v66, v187, v183, s57
    v_perm_b32 v39, v192, v188, s56
    v_perm_b32 v43, v192, v188, s57
    v_perm_b32 v47, v193, v189, s56
    v_perm_b32 v51, v193, v189, s57
    v_perm_b32 v55, v194, v190, s56
    v_perm_b32 v59, v194, v190, s57
    v_perm_b32 v63, v195, v191, s56
    v_perm_b32 v67, v195, v191, s57
    s_sub_u32 s34, s58, 128
    s_branch L_poll_10_ld
L_poll_10:
    s_cmp_lg_u32 s34, s58
    s_cbranch_scc1 L_poll_10_ld
    s_mov_b64 s[70:71], exec
    s_mov_b64 exec, -1
    v_subrev_u32 v4, 0x280000, v4
    s_mov_b64 exec, s[70:71]
    s_mov_b32 s34, -1
L_poll_10_ld:
    buffer_load_dwordx4 v[68:71], v4, s[8:11], 0 offen offset:0 sc1
    buffer_load_dwordx4 v[72:75], v4, s[8:11], 0 offen offset:1024 sc1
    s_sub_u32 s58, s58, 1
    s_cbranch_scc1 L_end
L_chk_11:
    s_waitcnt vmcnt(0)
L_chk_11_w:
    v_cmp_ne_u32 vcc, v71, v5
    v_cmp_ne_u32 s[70:71], v75, v5
    s_or_b64 vcc, vcc, s[70:71]
    s_cbranch_vccnz L_poll_10
    v_lshlrev_b32 v76, 16, v68
    v_and_b32 v77, 0xffff0000, v68
    v_lshlrev_b32 v78, 16, v69
    v_and_b32 v79, 0xffff0000, v69
    v_pk_mul_f32 v[84:85], v[76:77], v[196:197]
    v_pk_mul_f32 v[86:87], v[78:79], v[198:199]
    v_cvt_pk_bf16_f32 v88, v84, v85
    v_cvt_pk_bf16_f32 v89, v86, v87
    v_lshlrev_b32 v12, 16, v88
    v_and_b32 v13, 0xffff0000, v88
    v_lshlrev_b32 v14, 16, v89
    v_and_b32 v15, 0xffff0000, v89
    v_pk_add_f32 v[84:85], v[84:85], v[12:13] neg_lo:[0,1] neg_hi:[0,1]
    v_pk_add_f32 v[86:87], v[86:87], v[14:15] neg_lo:[0,1] neg_hi:[0,1]
    v_cvt_pk_bf16_f32 v90, v84, v85
    v_cvt_pk_bf16_f32 v91, v86, v87
    s_not_b64 vcc, s[66:67]
    v_cndmask_b32_dpp v14, v88, v90, vcc quad_perm:[2,3,2,3] row_mask:0xf bank_mask:0xf
    v_cndmask_b32_dpp v15, v89, v91, vcc quad_perm:[2,3,2,3] row_mask:0xf bank_mask:0xf
    s_mov_b64 vcc, s[66:67]
    v_cndmask_b32_dpp v12, v90, v88, vcc quad_perm:[0,1,0,1] row_mask:0xf bank_mask:0xf
    v_cndmask_b32_dpp v13, v91, v89, vcc quad_perm:[0,1,0,1] row_mask:0xf bank_mask:0xf
    v_lshlrev_b32 v80, 16, v72
    v_and_b32 v81, 0xffff0000, v72
    v_mfma_f32_16x16x32_bf16 v[164:167], v[12:15], v[100:103], 0
    v_lshlrev_b32 v82, 16, v73
    v_and_b32 v83, 0xffff0000, v73
    v_pk_mul_f32 v[92:93], v[80:81], v[200:201]
    v_mfma_f32_16x16x32_bf16 v[180:183], v[12:15], v[116:119], 0
    v_pk_mul_f32 v[94:95], v[82:83], v[202:203]
    v_cvt_pk_bf16_f32 v96, v92, v93
    v_cvt_pk_bf16_f32 v97, v94, v95
    v_mfma_f32_16x16x32_bf16 v[168:171], v[12:15], v[104:107], 0
    v_lshlrev_b32 v16, 16, v96
    v_and_b32 v17, 0xffff0000, v96
    v_lshlrev_b32 v18, 16, v97
    v_mfma_f32_16x16x32_bf16 v[184:187], v[12:15], v[120:123], 0
    v_and_b32 v19, 0xffff0000, v97
    v_pk_add_f32 v[92:93], v[92:93], v[16:17] neg_lo:[0,1] neg_hi:[0,1]
    v_pk_add_f32 v[94:95], v[94:95], v[18:19] neg_lo:[0,1] neg_hi:[0,1]
    v_mfma_f32_16x16x32_bf16 v[172:175], v[12:15], v[108:111], 0
    v_cvt_pk_bf16_f32 v98, v92, v93
    v_cvt_pk_bf16_f32 v99, v94, v95
    s_not_b64 vcc, s[66:67]
    v_mfma_f32_16x16x32_bf16 v[188:191], v[12:15], v[124:127], 0
    v_cndmask_b32_dpp v18, v96, v98, vcc quad_perm:[2,3,2,3] row_mask:0xf bank_mask:0xf
    v_cndmask_b32_dpp v19, v97, v99, vcc quad_perm:[2,3,2,3] row_mask:0xf bank_mask:0xf
    s_mov_b64 vcc, s[66:67]
    v_mfma_f32_16x16x32_bf16 v[176:179], v[12:15], v[112:115], 0
    v_cndmask_b32_dpp v16, v98, v96, vcc quad_perm:[0,1,0,1] row_mask:0xf bank_mask:0xf
    v_cndmask_b32_dpp v17, v99, v97, vcc quad_perm:[0,1,0,1] row_mask:0xf bank_mask:0xf
    v_mfma_f32_16x16x32_bf16 v[192:195], v[12:15], v[128:131], 0
    v_pk_add_f32 v[222:223], v[76:77], v[78:79]
    v_pk_mul_f32 v[224:225], v[76:77], v[76:77]
    v_mfma_f32_16x16x32_bf16 v[164:167], v[16:19], v[132:135], v[164:167]
    v_pk_add_f32 v[222:223], v[222:223], v[80:81]
    v_pk_fma_f32 v[224:225], v[78:79], v[78:79], v[224:225]
    v_mfma_f32_16x16x32_bf16 v[180:183], v[16:19], v[148:151], v[180:183]
    v_pk_add_f32 v[222:223], v[222:223], v[82:83]
    v_pk_fma_f32 v[224:225], v[80:81], v[80:81], v[224:225]
    v_mfma_f32_16x16x32_bf16 v[168:171], v[16:19], v[136:139], v[168:171]
    v_add_f32 v228, v222, v223
    v_pk_fma_f32 v[224:225], v[82:83], v[82:83], v[224:225]
    v_mfma_f32_16x16x32_bf16 v[184:187], v[16:19], v[152:155], v[184:187]
    v_add_f32 v229, v224, v225
    s_nop 0
    v_mfma_f32_16x16x32_bf16 v[172:175], v[16:19], v[140:143], v[172:175]
    v_permlane32_swap_b32 v228, v229
    v_add_f32 v228, v228, v229
    v_mfma_f32_16x16x32_bf16 v[188:191], v[16:19], v[156:159], v[188:191]
    v_mov_b32 v229, v228
    s_nop 0
    v_mfma_f32_16x16x32_bf16 v[176:179], v[16:19], v[144:147], v[176:179]
    v_permlane16_swap_b32 v228, v229
    v_add_f32 v228, v228, v229
    v_mfma_f32_16x16x32_bf16 v[192:195], v[16:19], v[160:163], v[192:195]
    v_pk_add_f32 v[164:165], v[164:165], v[166:167]
    v_add_f32_dpp v228, v228, v228 quad_perm:[1,0,3,2] row_mask:0xf bank_mask:0xf
    v_pk_add_f32 v[180:181], v[180:181], v[182:183]
    v_pk_add_f32 v[168:169], v[168:169], v[170:171]
    v_add_f32_dpp v228, v228, v228 quad_perm:[2,3,0,1] row_mask:0xf bank_mask:0xf
    v_pk_add_f32 v[184:185], v[184:185], v[186:187]
    v_pk_add_f32 v[172:173], v[172:173], v[174:175]
    ds_write_b32 v3, v228 offset:4160
L_pad_8:
    s_cbranch_execz L_warm_done
    v_pk_add_f32 v[188:189], v[188:189], v[190:191]
    s_nop 0
    v_pk_add_f32 v[176:177], v[176:177], v[178:179]
    v_pk_add_f32 v[192:193], v[192:193], v[194:195]
    v_add_f32_dpp v220, v165, v164 row_ror:8 row_mask:0xf bank_mask:0x3
    v_add_f32_dpp v220, v180, v181 row_ror:8 row_mask:0xf bank_mask:0xc
    v_add_f32_dpp v221, v169, v168 row_ror:8 row_mask:0xf bank_mask:0x3
    v_add_f32_dpp v221, v184, v185 row_ror:8 row_mask:0xf bank_mask:0xc
    v_add_f32_dpp v222, v173, v172 row_ror:8 row_mask:0xf bank_mask:0x3
    v_add_f32_dpp v222, v188, v189 row_ror:8 row_mask:0xf bank_mask:0xc
    v_add_f32_dpp v223, v177, v176 row_ror:8 row_mask:0xf bank_mask:0x3
    v_add_f32_dpp v223, v192, v193 row_ror:8 row_mask:0xf bank_mask:0xc
    ds_write_b128 v6, v[220:223] offset:12480
    s_waitcnt lgkmcnt(0)
    s_barrier
    ds_read_b128 v[228:231], v10 offset:4160
    ds_read_b128 v[232:235], v10 offset:4176
    ds_read_b128 v[220:223], v7 offset:12480
    s_waitcnt lgkmcnt(1)
    v_pk_add_f32 v[228:229], v[228:229], v[230:231]
    v_pk_add_f32 v[232:233], v[232:233], v[234:235]
    v_pk_add_f32 v[228:229], v[228:229], v[232:233]
    v_mul_f32 v228, 0x3b000000, v228
    v_mul_f32 v229, 0x3b000000, v229
    v_fma_f32 v229, -v228, v228, v229
    v_max_f32 v229, 0, v229
    v_cvt_pk_bf16_f32 v230, v228, v229
    v_lshlrev_b32 v228, 16, v230
    v_and_b32 v229, 0xffff0000, v230
    v_add_f32 v229, 0x3727c5ac, v229
    v_cvt_pk_bf16_f32 v229, v229, v229
    v_lshlrev_b32 v229, 16, v229
    v_sqrt_f32 v229, v229
    s_nop 0
    v_cvt_pk_bf16_f32 v229, v229, v229
    v_lshlrev_b32 v229, 16, v229
    v_rcp_f32 v229, v229
    s_waitcnt lgkmcnt(0)
    v_permlane32_swap_b32 v220, v222
    v_permlane32_swap_b32 v221, v223
    v_add_f32 v220, v220, v222
    v_add_f32 v221, v221, v223
    s_nop 1
    v_permlane16_swap_b32 v220, v221
    v_add_f32 v220, v220, v221
    v_fma_f32 v220, -v228, v32, v220
    v_fma_f32 v220, v220, v229, v33
    v_cvt_pk_bf16_f32 v220, v220, v220
    v_lshlrev_b32 v220, 16, v220
    v_mul_f32 v222, 0x3fb8aa3b, v220
    v_exp_f32 v222, -v222
    v_mov_b32_dpp v221, v220 row_shl:4 row_mask:0xf bank_mask:0xf
    v_add_f32 v222, 1.0, v222
    v_rcp_f32 v222, v222
    s_mov_b32 exec_lo, 0xf0f0f0f
    s_mov_b32 exec_hi, 0xf0f0f0f
    v_mul_f32 v220, v220, v222
    v_cvt_pk_bf16_f32 v220, v220, v220
    v_lshlrev_b32 v220, 16, v220
    v_mul_f32 v220, v220, v221
    v_cvt_pk_bf16_f32 v220, v220, v220
    ds_write_b16 v11, v220 offset:16576
    s_mov_b64 exec, -1
    s_waitcnt lgkmcnt(0)
    s_barrier
    ds_read_b128 v[220:223], v26 offset:16576
    s_waitcnt lgkmcnt(0)
    v_mfma_f32_16x16x32_bf16 v[164:167], v[220:223], v[36:39], 0
    v_mfma_f32_16x16x32_bf16 v[168:171], v[220:223], v[40:43], 0
    v_mfma_f32_16x16x32_bf16 v[172:175], v[220:223], v[44:47], 0
    v_mfma_f32_16x16x32_bf16 v[176:179], v[220:223], v[48:51], 0
    v_mfma_f32_16x16x32_bf16 v[180:183], v[220:223], v[52:55], 0
    v_mfma_f32_16x16x32_bf16 v[184:187], v[220:223], v[56:59], 0
    v_mfma_f32_16x16x32_bf16 v[188:191], v[220:223], v[60:63], 0
    v_mfma_f32_16x16x32_bf16 v[192:195], v[220:223], v[64:67], 0
    s_mov_b32 vcc_lo, 0x55555555
    s_mov_b32 vcc_hi, 0x55555555
    v_mov_b32 v223, v5
    v_mov_b32 v227, v5
    v_perm_b32 v165, v168, v176, s21
    v_perm_b32 v166, v172, v176, s22
    v_perm_b32 v164, v164, v176, s20
    s_nop 0
    v_perm_b32 v181, v184, v192, s21
    v_perm_b32 v182, v188, v192, s22
    v_perm_b32 v180, v180, v192, s20
    s_nop 0
    v_cndmask_b32_dpp v221, v181, v165, vcc quad_perm:[1,0,3,2] row_mask:0xf bank_mask:0xf
    v_cndmask_b32_dpp v222, v182, v166, vcc quad_perm:[1,0,3,2] row_mask:0xf bank_mask:0xf
    v_cndmask_b32_dpp v220, v180, v164, vcc quad_perm:[1,0,3,2] row_mask:0xf bank_mask:0xf
    buffer_store_dwordx4 v[220:223], v27, s[8:11], s62 offen sc1
    s_not_b64 vcc, vcc
    v_cndmask_b32_dpp v225, v165, v181, vcc quad_perm:[1,0,3,2] row_mask:0xf bank_mask:0xf
    v_cndmask_b32_dpp v226, v166, v182, vcc quad_perm:[1,0,3,2] row_mask:0xf bank_mask:0xf
    v_cndmask_b32_dpp v224, v164, v180, vcc quad_perm:[1,0,3,2] row_mask:0xf bank_mask:0xf
    buffer_store_dwordx4 v[224:227], v27, s[8:11], s61 offen sc1
    s_lshl_b32 s7, s38, 2
    s_or_b32 s7, s7, s3
    s_cbranch_scc1 L_nofl_12
    s_lshl_b32 s7, s5, 7
    s_add_u32 s7, s7, 0x3e0000
    v_mov_b32 v8, 0
    buffer_store_dword v5, v8, s[8:11], s7 offen
L_nofl_12:
    s_branch L_end
    .fill 102, 4, 0xbf800000
L_A:
L_pad_9:
    s_cbranch_execz L_pad_13
    s_add_u32 s47, s46, 12288
    buffer_load_dwordx4 a[48:51], v7, s[16:19], s47 offen offset:0 nt
    buffer_load_dwordx4 a[52:55], v7, s[16:19], s47 offen offset:1024 nt
    buffer_load_dwordx4 a[56:59], v7, s[16:19], s47 offen offset:2048 nt
    buffer_load_dwordx4 a[60:63], v7, s[16:19], s47 offen offset:3072 nt
    s_add_u32 s47, s46, 0
    buffer_load_dwordx4 v[32:35], v7, s[20:23], s47 offen offset:0 nt
    buffer_load_dwordx4 v[36:39], v7, s[20:23], s47 offen offset:1024 nt
    buffer_load_dwordx4 v[40:43], v7, s[20:23], s47 offen offset:2048 nt
    buffer_load_dwordx4 v[44:47], v7, s[20:23], s47 offen offset:3072 nt
    s_add_u32 s47, s46, 4096
    buffer_load_dwordx4 v[48:51], v7, s[20:23], s47 offen offset:0 nt
    buffer_load_dwordx4 v[52:55], v7, s[20:23], s47 offen offset:1024 nt
    buffer_load_dwordx4 v[56:59], v7, s[20:23], s47 offen offset:2048 nt
    buffer_load_dwordx4 v[60:63], v7, s[20:23], s47 offen offset:3072 nt
    s_mov_b32 s6, s7
    s_load_dwordx2 s[28:29], s[0:1], 32
    s_load_dwordx2 s[52:53], s[0:1], 88
    s_load_dword s4, s[8:9], 0
    s_lshl4_add_u32 s63, s5, s6
    s_lshl2_add_u32 s7, s5, s59
    s_lshl_b32 s7, s7, 11
    s_add_u32 s7, s7, 0x370000
    v_add_u32 v1, s7, v7
    s_lshr_b32 s7, s6, 3
    s_lshl1_add_u32 s7, s5, s7
    s_lshl_b32 s7, s7, 14
    s_lshr_b32 s62, s3, 1
    s_lshl_b32 s62, s62, 13
    s_add_u32 s7, s7, s62
    s_and_b32 s62, s3, 1
    s_lshl_b32 s62, s62, 8
    s_add_u32 s7, s7, s62
    s_add_u32 s7, s7, 0x380000
    v_bfe_u32 v10, v0, 1, 3
    v_lshlrev_b32 v23, 10, v10
    v_and_b32 v10, 1, v0
    v_lshl_add_u32 v23, v10, 6, v23
    v_lshrrev_b32 v10, 4, v0
    v_lshl_add_u32 v23, v10, 4, v23
    v_add_u32 v23, s7, v23
    v_lshrrev_b32 v10, 5, v0
    v_mul_u32_u24 v3, 272, v10
    v_and_b32 v10, 31, v0
    v_lshl_add_u32 v3, v10, 3, v3
    v_add_u32 v3, 65536, v3
    v_and_b32 v8, 15, v0
    v_lshrrev_b32 v9, 4, v0
    v_lshrrev_b32 v10, 2, v8
    v_mul_u32_u24 v4, 272, v10
    v_lshl_add_u32 v4, v9, 4, v4
    v_add_u32 v4, 65536, v4
    s_lshl_b32 s7, s3, 9
    s_add_u32 s7, s7, 66816
    v_lshlrev_b32 v200, 7, v9
    v_lshl_add_u32 v200, v8, 2, v200
    v_add_u32 v200, s7, v200
    v_lshlrev_b32 v201, 7, v10
    v_lshl_add_u32 v201, v9, 4, v201
    v_add_u32 v201, s7, v201
    v_lshlrev_b32 v10, 2, v9
    v_xor_b32 v10, v10, v8
    v_lshlrev_b32 v11, 8, v9
    s_lshl_b32 s7, s3, 14
    v_add_u32 v11, s7, v11
    v_xor_b32 v28, 0, v10
    v_lshl_add_u32 v28, v28, 4, v11
    v_xor_b32 v29, 1, v10
    v_lshl_add_u32 v29, v29, 4, v11
    v_xor_b32 v30, 2, v10
    v_lshl_add_u32 v30, v30, 4, v11
    v_xor_b32 v31, 3, v10
    v_lshl_add_u32 v31, v31, 4, v11
    v_mul_u32_u24 v5, 640, v9
    v_mad_u32_u24 v5, v8, 40, v5
    s_mul_i32 s7, s3, 2560
    s_add_u32 s7, s7, 68864
    v_add_u32 v5, s7, v5
    v_lshlrev_b32 v6, 5, v9
    s_lshl_b32 s7, s3, 3
    s_add_u32 s7, s7, 66688
    v_add_u32 v6, s7, v6
    v_and_b32 v10, 3, v0
    v_lshlrev_b32 v10, 3, v10
    s_lshl_b32 s7, s3, 5
    s_add_u32 s7, s7, 66688
    v_add_u32 v20, s7, v10
    v_lshrrev_b32 v11, 2, v0
    v_mad_u32_u24 v21, v11, 40, v10
    s_mul_i32 s7, s3, 640
    s_add_u32 s7, s7, 68864
    v_add_u32 v21, s7, v21
    s_lshl2_add_u32 s7, s5, s3
    s_lshl4_add_u32 s7, s7, s6
    s_lshl_b32 s7, s7, 9
    s_add_u32 s7, s7, 0x100000
    v_lshrrev_b32 v10, 5, v0
    v_lshlrev_b32 v22, 8, v10
    v_and_b32 v10, 2, v0
    v_lshl_add_u32 v22, v10, 6, v22
    v_and_b32 v10, 28, v0
    v_lshl_add_u32 v22, v10, 2, v22
    v_add_u32 v22, s7, v22
    s_lshr_b32 s68, s6, 3
    s_lshl1_add_u32 s68, s5, s68
    s_lshl2_add_u32 s60, s68, s3
    s_lshl_b32 s62, s60, 16
    s_and_b32 s61, s6, 7
    s_lshl_b32 s7, s61, 7
    s_add_u32 s69, s62, s7
    v_bfe_u32 v10, v0, 3, 1
    v_lshl_add_u32 v11, v10, 2, v9
    v_lshlrev_b32 v27, 13, v11
    v_and_b32 v11, 7, v0
    v_lshl_add_u32 v27, v11, 4, v27
    v_lshlrev_b32 v24, 11, v11
    v_lshl_add_u32 v24, v10, 6, v24
    v_lshl_add_u32 v24, v9, 4, v24
    s_lshl_b32 s7, s61, 14
    s_lshl_b32 s62, s68, 7
    s_add_u32 s7, s7, s62
    s_add_u32 s7, s7, 0x180000
    v_add_u32 v24, s7, v24
    s_lshl_b32 s7, s3, 10
    v_add_u32 v25, s7, v7
    s_mov_b32 s30, 0x400000
    s_mov_b32 s31, 0x20000
    s_mov_b32 s14, 0x1000
    s_mov_b32 s15, 0x20000
    s_mov_b32 s54, 0x1000
    s_mov_b32 s55, 0x20000
    s_lshl2_add_u32 s63, s6, s3
    v_and_b32 v10, 3, v0
    v_lshlrev_b32 v236, 10, v10
    v_lshrrev_b32 v11, 4, v0
    v_lshl_add_u32 v236, v11, 1, v236
    v_and_b32 v11, 4, v0
    v_lshl_add_u32 v236, v11, 1, v236
    s_lshl_b32 s60, s63, 4
    s_lshl_b32 s7, s63, 11
    s_add_u32 s7, s7, 0x180000
    v_add_u32 v237, s7, v7
    s_lshl_b32 s7, s5, 17
    v_add_u32 v237, s7, v237
    s_lshl_b32 s59, s63, 7
    v_and_b32 v239, 0x70, v7
    v_add_u32 v239, s59, v239
    v_add_u32 v240, 0xc0000, v239
    v_add_u32 v239, 0x60000, v239
    s_mul_i32 s7, s5, 0x2100
    s_add_u32 s59, s59, s7
    s_add_u32 s59, s59, 0x140000
    v_add_u32 v238, s59, v7
    s_lshl_b32 s51, s3, 1
    s_mul_i32 s7, s63, 7168
    s_add_u32 s7, s7, 0x290000
    v_add_u32 v234, s7, v7
    v_add_u32 v235, 4096, v234
    s_mov_b32 s64, 0x3db504f3
    s_mov_b32 s65, 0x3db504f3
    s_mov_b32 s66, 0x3fb8aa3b
    s_mov_b32 s67, 0x3fb8aa3b
    s_add_u32 s61, s69, 4096
    s_mov_b32 s50, 0x280000
    s_waitcnt lgkmcnt(0)
    s_add_u32 s47, s46, 8192
    buffer_load_dwordx4 v[64:67], v7, s[20:23], s47 offen offset:0 nt
    buffer_load_dwordx4 v[68:71], v7, s[20:23], s47 offen offset:1024 nt
    buffer_load_dwordx4 v[72:75], v7, s[20:23], s47 offen offset:2048 nt
    buffer_load_dwordx4 v[76:79], v7, s[20:23], s47 offen offset:3072 nt
    s_add_u32 s47, s46, 12288
    buffer_load_dwordx4 v[80:83], v7, s[20:23], s47 offen offset:0 nt
    buffer_load_dwordx4 v[84:87], v7, s[20:23], s47 offen offset:1024 nt
    buffer_load_dwordx4 v[88:91], v7, s[20:23], s47 offen offset:2048 nt
    buffer_load_dwordx4 v[92:95], v7, s[20:23], s47 offen offset:3072 nt
    buffer_load_dwordx4 a[64:67], v27, s[28:31], s69 offen offset:0 nt
    buffer_load_dwordx4 a[68:71], v27, s[28:31], s69 offen offset:1024 nt
    buffer_load_dwordx4 a[72:75], v27, s[28:31], s69 offen offset:2048 nt
    buffer_load_dwordx4 a[76:79], v27, s[28:31], s69 offen offset:3072 nt
    s_mul_i32 s4, s4, 0x9E3779B1
L_pad_10:
    s_cbranch_execz L_pad_14
    s_add_u32 s4, s4, 0x7F4A7C15
    v_mov_b32 v2, s4
    s_waitcnt vmcnt(35)
    ds_write_b128 v28, a[0:3] offset:0
    s_waitcnt vmcnt(34)
    ds_write_b128 v28, a[4:7] offset:1024
    s_waitcnt vmcnt(33)
    ds_write_b128 v29, a[8:11] offset:2048
    s_waitcnt vmcnt(32)
    ds_write_b128 v29, a[12:15] offset:3072
    s_waitcnt vmcnt(31)
    ds_write_b128 v30, a[16:19] offset:4096
    s_waitcnt vmcnt(30)
    ds_write_b128 v30, a[20:23] offset:5120
    s_waitcnt vmcnt(29)
    ds_write_b128 v31, a[24:27] offset:6144
    s_waitcnt vmcnt(28)
    ds_write_b128 v31, a[28:31] offset:7168
    s_waitcnt vmcnt(27)
    ds_write_b128 v28, a[32:35] offset:8192
    s_waitcnt vmcnt(26)
    ds_write_b128 v28, a[36:39] offset:9216
    s_waitcnt vmcnt(25)
    ds_write_b128 v29, a[40:43] offset:10240
    s_waitcnt vmcnt(24)
    ds_write_b128 v29, a[44:47] offset:11264
    s_waitcnt vmcnt(23)
    ds_write_b128 v30, a[48:51] offset:12288
    s_waitcnt vmcnt(22)
    ds_write_b128 v30, a[52:55] offset:13312
    s_waitcnt vmcnt(21)
    ds_write_b128 v31, a[56:59] offset:14336
    s_waitcnt vmcnt(20)
    ds_write_b128 v31, a[60:63] offset:15360
    s_cmp_lg_u32 s3, 3
    s_cbranch_scc1 L_noql_13
    buffer_load_dwordx4 v[12:15], v1, s[8:11], 0 offen offset:0 sc1
    buffer_load_dwordx4 v[16:19], v1, s[8:11], 0 offen offset:1024 sc1
L_noql_13:
    v_and_b32 v10, 3, v8
    v_lshlrev_b32 v10, 3, v10
    v_lshrrev_b32 v11, 2, v8
    v_add_lshl_u32 v11, v10, v11, 8
    s_lshl_b32 s7, s3, 14
    v_add_u32 v11, s7, v11
    v_xor_b32 v10, v8, v9
    s_waitcnt lgkmcnt(0)
    v_xor_b32 v28, 0, v10
    v_lshl_add_u32 v28, v28, 4, v11
    v_xor_b32 v29, 4, v10
    v_lshl_add_u32 v29, v29, 4, v11
    v_xor_b32 v30, 8, v10
    v_lshl_add_u32 v30, v30, 4, v11
    v_xor_b32 v31, 12, v10
    v_lshl_add_u32 v31, v31, 4, v11
    ds_read_b128 a[0:3], v28 offset:0
    ds_read_b128 a[4:7], v29 offset:0
    ds_read_b128 a[8:11], v30 offset:0
    ds_read_b128 a[12:15], v31 offset:0
    ds_read_b128 a[16:19], v28 offset:1024
    ds_read_b128 a[20:23], v29 offset:1024
    ds_read_b128 a[24:27], v30 offset:1024
    ds_read_b128 a[28:31], v31 offset:1024
    ds_read_b128 a[32:35], v28 offset:8192
    ds_read_b128 a[36:39], v29 offset:8192
    ds_read_b128 a[40:43], v30 offset:8192
    ds_read_b128 a[44:47], v31 offset:8192
    ds_read_b128 a[48:51], v28 offset:9216
    ds_read_b128 a[52:55], v29 offset:9216
    ds_read_b128 a[56:59], v30 offset:9216
    ds_read_b128 a[60:63], v31 offset:9216
    s_waitcnt vmcnt(18)
    v_perm_b32 v96, v36, v32, s56
    v_perm_b32 v100, v36, v32, s57
    v_perm_b32 v104, v37, v33, s56
    v_perm_b32 v108, v37, v33, s57
    v_perm_b32 v112, v38, v34, s56
    v_perm_b32 v116, v38, v34, s57
    v_perm_b32 v120, v39, v35, s56
    v_perm_b32 v124, v39, v35, s57
    s_waitcnt vmcnt(16)
    v_perm_b32 v97, v44, v40, s56
    v_perm_b32 v101, v44, v40, s57
    v_perm_b32 v105, v45, v41, s56
    v_perm_b32 v109, v45, v41, s57
    v_perm_b32 v113, v46, v42, s56
    v_perm_b32 v117, v46, v42, s57
    v_perm_b32 v121, v47, v43, s56
    v_perm_b32 v125, v47, v43, s57
    s_waitcnt vmcnt(14)
    v_perm_b32 v98, v52, v48, s56
    v_perm_b32 v102, v52, v48, s57
    v_perm_b32 v106, v53, v49, s56
    v_perm_b32 v110, v53, v49, s57
    v_perm_b32 v114, v54, v50, s56
    v_perm_b32 v118, v54, v50, s57
    v_perm_b32 v122, v55, v51, s56
    v_perm_b32 v126, v55, v51, s57
    s_waitcnt vmcnt(12)
    v_perm_b32 v99, v60, v56, s56
    v_perm_b32 v103, v60, v56, s57
    v_perm_b32 v107, v61, v57, s56
    v_perm_b32 v111, v61, v57, s57
    v_perm_b32 v115, v62, v58, s56
    v_perm_b32 v119, v62, v58, s57
    v_perm_b32 v123, v63, v59, s56
    v_perm_b32 v127, v63, v59, s57
    s_waitcnt vmcnt(10)
    v_perm_b32 v128, v68, v64, s56
    v_perm_b32 v132, v68, v64, s57
    v_perm_b32 v136, v69, v65, s56
    v_perm_b32 v140, v69, v65, s57
    v_perm_b32 v144, v70, v66, s56
    v_perm_b32 v148, v70, v66, s57
    v_perm_b32 v152, v71, v67, s56
    v_perm_b32 v156, v71, v67, s57
    s_waitcnt vmcnt(8)
    v_perm_b32 v129, v76, v72, s56
    v_perm_b32 v133, v76, v72, s57
    v_perm_b32 v137, v77, v73, s56
    v_perm_b32 v141, v77, v73, s57
    v_perm_b32 v145, v78, v74, s56
    v_perm_b32 v149, v78, v74, s57
L_pad_11:
    s_cbranch_execz L_warm_done
    v_perm_b32 v153, v79, v75, s56
    v_perm_b32 v157, v79, v75, s57
    s_waitcnt vmcnt(6)
    v_perm_b32 v130, v84, v80, s56
    v_perm_b32 v134, v84, v80, s57
    v_perm_b32 v138, v85, v81, s56
    v_perm_b32 v142, v85, v81, s57
    v_perm_b32 v146, v86, v82, s56
    v_perm_b32 v150, v86, v82, s57
    v_perm_b32 v154, v87, v83, s56
    v_perm_b32 v158, v87, v83, s57
    s_waitcnt vmcnt(4)
    v_perm_b32 v131, v92, v88, s56
    v_perm_b32 v135, v92, v88, s57
    v_perm_b32 v139, v93, v89, s56
    v_perm_b32 v143, v93, v89, s57
    v_perm_b32 v147, v94, v90, s56
    v_perm_b32 v151, v94, v90, s57
    v_perm_b32 v155, v95, v91, s56
    v_perm_b32 v159, v95, v91, s57
    s_cmp_lg_u32 s3, 3
    s_cbranch_scc1 L_A_qk
    s_sub_u32 s34, s58, 128
    s_branch L_chk_15
L_poll_14:
    s_cmp_lg_u32 s34, s58
    s_cbranch_scc1 L_poll_14_ld
    s_mov_b64 s[70:71], exec
    s_mov_b64 exec, -1
    v_subrev_u32 v1, 0x280000, v1
    s_mov_b64 exec, s[70:71]
    s_mov_b32 s34, -1
L_poll_14_ld:
    buffer_load_dwordx4 v[12:15], v1, s[8:11], 0 offen offset:0 sc1
    buffer_load_dwordx4 v[16:19], v1, s[8:11], 0 offen offset:1024 sc1
    s_sub_u32 s58, s58, 1
    s_cbranch_scc1 L_end
L_chk_15:
    s_waitcnt vmcnt(0)
L_chk_15_w:
    v_cmp_ne_u32 vcc, v15, v2
    v_cmp_ne_u32 s[70:71], v19, v2
    s_or_b64 vcc, vcc, s[70:71]
    s_cbranch_vccnz L_poll_14
    ds_write_b64 v3, v[12:13]
    ds_write_b64 v3, v[16:17] offset:544
L_A_qk:
    s_waitcnt vmcnt(0)
    s_waitcnt lgkmcnt(0)
    s_barrier
    ds_read_b128 v[160:163], v4 offset:0
    ds_read_b128 v[164:167], v4 offset:64
    ds_read_b128 v[168:171], v4 offset:128
    ds_read_b128 v[172:175], v4 offset:192
    buffer_load_ushort v206, v236, s[12:15], s60 offen
    buffer_load_dwordx4 v[80:83], v27, s[28:31], s61 offen offset:0 nt
    buffer_load_dwordx4 v[84:87], v27, s[28:31], s61 offen offset:1024 nt
    s_waitcnt lgkmcnt(3)
    v_mfma_f32_16x16x32_bf16 v[176:179], v[160:163], a[0:3], 0
    buffer_load_dwordx4 v[88:91], v27, s[28:31], s61 offen offset:2048 nt
    v_mfma_f32_16x16x32_bf16 v[180:183], v[160:163], a[16:19], 0
    buffer_load_dwordx4 v[92:95], v27, s[28:31], s61 offen offset:3072 nt
    v_mfma_f32_16x16x32_bf16 v[184:187], v[160:163], a[32:35], 0
    v_mfma_f32_16x16x32_bf16 v[188:191], v[160:163], a[48:51], 0
    s_waitcnt lgkmcnt(2)
    v_mfma_f32_16x16x32_bf16 v[176:179], v[164:167], a[4:7], v[176:179]
    v_mfma_f32_16x16x32_bf16 v[180:183], v[164:167], a[20:23], v[180:183]
    v_mfma_f32_16x16x32_bf16 v[184:187], v[164:167], a[36:39], v[184:187]
    v_mfma_f32_16x16x32_bf16 v[188:191], v[164:167], a[52:55], v[188:191]
    s_waitcnt lgkmcnt(1)
    v_mfma_f32_16x16x32_bf16 v[176:179], v[168:171], a[8:11], v[176:179]
    v_mfma_f32_16x16x32_bf16 v[180:183], v[168:171], a[24:27], v[180:183]
    v_mfma_f32_16x16x32_bf16 v[184:187], v[168:171], a[40:43], v[184:187]
    v_mfma_f32_16x16x32_bf16 v[188:191], v[168:171], a[56:59], v[188:191]
    s_waitcnt lgkmcnt(0)
    v_mfma_f32_16x16x32_bf16 v[176:179], v[172:175], a[12:15], v[176:179]
    v_mfma_f32_16x16x32_bf16 v[180:183], v[172:175], a[28:31], v[180:183]
    v_mfma_f32_16x16x32_bf16 v[184:187], v[172:175], a[44:47], v[184:187]
    v_mfma_f32_16x16x32_bf16 v[188:191], v[172:175], a[60:63], v[188:191]
    s_nop 5
    v_cvt_pk_bf16_f32 v216, v176, v180
    v_max_f32 v210, v176, v180
    v_max3_f32 v210, v210, v184, v188
    v_cvt_pk_bf16_f32 v217, v184, v188
    v_lshlrev_b32 v212, 16, v216
    v_max_f32_dpp v210, v210, v210 row_ror:8 row_mask:0xf bank_mask:0xf
    v_and_b32 v213, 0xffff0000, v216
    v_lshlrev_b32 v214, 16, v217
    v_max_f32_dpp v210, v210, v210 row_ror:4 row_mask:0xf bank_mask:0xf
    v_and_b32 v215, 0xffff0000, v217
    v_pk_mul_f32 v[212:213], v[212:213], s[64:65]
    v_max_f32_dpp v210, v210, v210 row_ror:2 row_mask:0xf bank_mask:0xf
    v_pk_mul_f32 v[214:215], v[214:215], s[64:65]
    v_cvt_pk_bf16_f32 v216, v212, v213
    v_max_f32_dpp v210, v210, v210 row_ror:1 row_mask:0xf bank_mask:0xf
    v_cvt_pk_bf16_f32 v217, v214, v215
    v_cvt_pk_bf16_f32 v210, v210, v210
    v_lshlrev_b32 v210, 16, v210
    v_lshlrev_b32 v212, 16, v216
    v_and_b32 v213, 0xffff0000, v216
    v_mul_f32 v210, s64, v210
    v_lshlrev_b32 v214, 16, v217
    v_and_b32 v215, 0xffff0000, v217
    v_cvt_pk_bf16_f32 v210, v210, v210
    v_lshlrev_b32 v210, 16, v210
    v_mul_f32 v216, 0xbfb8aa3b, v210
    v_pk_fma_f32 v[212:213], v[212:213], s[66:67], v[216:217] op_sel_hi:[1,1,0]
    v_pk_fma_f32 v[214:215], v[214:215], s[66:67], v[216:217] op_sel_hi:[1,1,0]
    v_exp_f32 v212, v212
    v_exp_f32 v213, v213
    v_exp_f32 v214, v214
    v_exp_f32 v215, v215
    v_cvt_pk_bf16_f32 v216, v212, v213
    v_cvt_pk_bf16_f32 v217, v214, v215
    ds_write2_b32 v200, v216, v217 offset0:0 offset1:16
    ds_read_b128 v[192:195], v201
    ds_read_b128 v[196:199], v201 offset:64
    v_pk_add_f32 v[212:213], v[212:213], v[214:215]
    v_add_f32 v211, v212, v213
    s_nop 1
    v_add_f32_dpp v211, v211, v211 row_ror:8 row_mask:0xf bank_mask:0xf
    s_nop 1
    v_add_f32_dpp v211, v211, v211 row_ror:4 row_mask:0xf bank_mask:0xf
    s_nop 1
    v_add_f32_dpp v211, v211, v211 row_ror:2 row_mask:0xf bank_mask:0xf
    s_nop 1
    v_add_f32_dpp v211, v211, v211 row_ror:1 row_mask:0xf bank_mask:0xf
    s_waitcnt lgkmcnt(0)
    v_mfma_f32_16x16x32_bf16 v[32:35], v[192:195], v[96:99], 0
    v_mfma_f32_16x16x32_bf16 v[36:39], v[192:195], v[100:103], 0
    v_mfma_f32_16x16x32_bf16 v[40:43], v[192:195], v[104:107], 0
    v_mfma_f32_16x16x32_bf16 v[44:47], v[192:195], v[108:111], 0
    v_mfma_f32_16x16x32_bf16 v[48:51], v[192:195], v[112:115], 0
    v_mfma_f32_16x16x32_bf16 v[52:55], v[192:195], v[116:119], 0
    v_mfma_f32_16x16x32_bf16 v[56:59], v[192:195], v[120:123], 0
    v_mfma_f32_16x16x32_bf16 v[60:63], v[192:195], v[124:127], 0
    v_mfma_f32_16x16x32_bf16 v[32:35], v[196:199], v[128:131], v[32:35]
    v_mfma_f32_16x16x32_bf16 v[36:39], v[196:199], v[132:135], v[36:39]
    v_mfma_f32_16x16x32_bf16 v[40:43], v[196:199], v[136:139], v[40:43]
    v_mfma_f32_16x16x32_bf16 v[44:47], v[196:199], v[140:143], v[44:47]
    v_mfma_f32_16x16x32_bf16 v[48:51], v[196:199], v[144:147], v[48:51]
    v_mfma_f32_16x16x32_bf16 v[52:55], v[196:199], v[148:151], v[52:55]
    v_mfma_f32_16x16x32_bf16 v[56:59], v[196:199], v[152:155], v[56:59]
    v_mfma_f32_16x16x32_bf16 v[60:63], v[196:199], v[156:159], v[60:63]
    ds_write_b64 v6, v[210:211]
    s_nop 3
    ds_write2_b32 v5, v32, v36 offset0:0 offset1:1
    ds_write2_b32 v5, v40, v44 offset0:2 offset1:3
    ds_write2_b32 v5, v48, v52 offset0:4 offset1:5
    ds_write2_b32 v5, v56, v60 offset0:6 offset1:7
    s_waitcnt lgkmcnt(0)
    s_barrier
    ds_read_b64 v[210:211], v20
    ds_read_b64 v[218:219], v21 offset:0
    ds_read_b64 v[220:221], v21 offset:2560
    ds_read_b64 v[222:223], v21 offset:5120
    ds_read_b64 v[224:225], v21 offset:7680
    s_waitcnt lgkmcnt(4)
    v_max_f32_dpp v212, v210, v210 quad_perm:[1,0,3,2] row_mask:0xf bank_mask:0xf
    v_mov_b32 v217, v2
    v_mov_b32 v216, 0x3fb8aa3b
    v_max_f32_dpp v212, v212, v212 quad_perm:[2,3,0,1] row_mask:0xf bank_mask:0xf
    v_sub_f32 v210, v210, v212
    v_mul_f32 v210, 0x3fb8aa3b, v210
    v_exp_f32 v210, v210
L_pad_12:
    s_cbranch_execz L_warm_done
    s_nop 0
    v_mul_f32 v211, v210, v211
    s_nop 1
    v_add_f32_dpp v211, v211, v211 quad_perm:[1,0,3,2] row_mask:0xf bank_mask:0xf
    s_nop 1
    v_add_f32_dpp v211, v211, v211 quad_perm:[2,3,0,1] row_mask:0xf bank_mask:0xf
    v_rcp_f32 v213, v211
    v_log_f32 v211, v211
    v_mul_f32 v210, v210, v213
    v_fma_f32 v216, v212, v216, v211
    v_readlane_b32 s32, v210, 0
    v_readlane_b32 s34, v210, 1
    v_readlane_b32 s36, v210, 2
    v_readlane_b32 s38, v210, 3
    s_waitcnt lgkmcnt(0)
    v_pk_mul_f32 v[212:213], v[218:219], s[32:33] op_sel_hi:[1,0]
    v_pk_fma_f32 v[212:213], v[220:221], s[34:35], v[212:213] op_sel_hi:[1,0,1]
    v_pk_fma_f32 v[212:213], v[222:223], s[36:37], v[212:213] op_sel_hi:[1,0,1]
    v_pk_fma_f32 v[212:213], v[224:225], s[38:39], v[212:213] op_sel_hi:[1,0,1]
    v_cvt_pk_bf16_f32 v214, v212, v213
    s_nop 1
    v_mov_b32_dpp v215, v214 quad_perm:[1,0,3,2] row_mask:0xf bank_mask:0xf
    s_mov_b32 exec_lo, 0x55555555
    s_mov_b32 exec_hi, 0x55555555
    buffer_store_dwordx4 v[214:217], v22, s[8:11], s50 offen
    s_mov_b64 exec, -1
    v_mov_b64 v[12:13], v[214:215]
    v_mov_b64 v[14:15], v[216:217]
    s_mov_b32 s64, 0x07060501
    s_mov_b32 s65, 0x07060502
    s_mov_b32 s66, 0x07060503
    buffer_load_dwordx4 v[32:35], v23, s[8:11], 0 offen offset:0 sc1
    buffer_load_dwordx4 v[36:39], v23, s[8:11], 0 offen offset:128 sc1
    buffer_load_dwordx4 v[40:43], v23, s[8:11], 0 offen offset:512 sc1
    buffer_load_dwordx4 v[44:47], v23, s[8:11], 0 offen offset:640 sc1
    v_accvgpr_read_b32 v64, a64
    v_accvgpr_read_b32 v65, a65
    v_accvgpr_read_b32 v66, a66
    v_accvgpr_read_b32 v67, a67
    v_accvgpr_read_b32 v68, a68
    v_accvgpr_read_b32 v69, a69
    v_accvgpr_read_b32 v70, a70
    v_accvgpr_read_b32 v71, a71
    v_accvgpr_read_b32 v72, a72
    v_accvgpr_read_b32 v73, a73
    v_accvgpr_read_b32 v74, a74
    v_accvgpr_read_b32 v75, a75
    v_accvgpr_read_b32 v76, a76
    v_accvgpr_read_b32 v77, a77
    v_accvgpr_read_b32 v78, a78
    v_accvgpr_read_b32 v79, a79
    s_waitcnt vmcnt(9)
    v_perm_b32 v160, v68, v64, s56
    v_perm_b32 v164, v68, v64, s57
    v_perm_b32 v168, v69, v65, s56
    v_perm_b32 v172, v69, v65, s57
    v_perm_b32 v176, v70, v66, s56
    v_perm_b32 v180, v70, v66, s57
    v_perm_b32 v184, v71, v67, s56
    v_perm_b32 v188, v71, v67, s57
    s_waitcnt vmcnt(9)
    v_perm_b32 v161, v76, v72, s56
    v_perm_b32 v165, v76, v72, s57
    v_perm_b32 v169, v77, v73, s56
    v_perm_b32 v173, v77, v73, s57
    v_perm_b32 v177, v78, v74, s56
    v_perm_b32 v181, v78, v74, s57
    v_perm_b32 v185, v79, v75, s56
    v_perm_b32 v189, v79, v75, s57
    s_waitcnt vmcnt(7)
    v_perm_b32 v162, v84, v80, s56
    v_perm_b32 v166, v84, v80, s57
    v_perm_b32 v170, v85, v81, s56
    v_perm_b32 v174, v85, v81, s57
    v_perm_b32 v178, v86, v82, s56
    v_perm_b32 v182, v86, v82, s57
    v_perm_b32 v186, v87, v83, s56
    v_perm_b32 v190, v87, v83, s57
    s_waitcnt vmcnt(5)
    v_perm_b32 v163, v92, v88, s56
    v_perm_b32 v167, v92, v88, s57
    v_perm_b32 v171, v93, v89, s56
    v_perm_b32 v175, v93, v89, s57
    v_perm_b32 v179, v94, v90, s56
    v_perm_b32 v183, v94, v90, s57
    v_perm_b32 v187, v95, v91, s56
    v_perm_b32 v191, v95, v91, s57
    s_sub_u32 s34, s58, 128
    s_branch L_chk_17
L_poll_16:
    s_cmp_lg_u32 s34, s58
    s_cbranch_scc1 L_poll_16_ld
    s_mov_b64 s[70:71], exec
    s_mov_b64 exec, -1
    v_subrev_u32 v23, 0x280000, v23
    s_mov_b32 exec_lo, 0x55555555
    s_mov_b32 exec_hi, 0x55555555
    buffer_store_dwordx4 v[12:15], v22, s[8:11], 0 offen sc1
    s_mov_b64 exec, -1
    s_mov_b64 exec, s[70:71]
    s_mov_b32 s34, -1
L_poll_16_ld:
    buffer_load_dwordx4 v[32:35], v23, s[8:11], 0 offen offset:0 sc1
    buffer_load_dwordx4 v[36:39], v23, s[8:11], 0 offen offset:128 sc1
    buffer_load_dwordx4 v[40:43], v23, s[8:11], 0 offen offset:512 sc1
    buffer_load_dwordx4 v[44:47], v23, s[8:11], 0 offen offset:640 sc1
    s_sub_u32 s58, s58, 1
    s_cbranch_scc1 L_end
L_chk_17:
    s_waitcnt vmcnt(0)
L_chk_17_w:
    v_min3_u32 v8, v35, v39, v43
    v_max3_u32 v9, v35, v39, v43
    v_min_u32 v8, v8, v47
    v_max_u32 v9, v9, v47
    v_cmp_ne_u32 vcc, v8, v2
    v_cmp_ne_u32 s[70:71], v9, v2
    s_or_b64 vcc, vcc, s[70:71]
    s_cbranch_vccnz L_poll_16
    v_max_f32 v210, v34, v42
    v_lshlrev_b32 v214, 16, v32
    v_and_b32 v215, 0xffff0000, v32
    v_max_f32_dpp v210, v210, v210 quad_perm:[2,3,0,1] row_mask:0xf bank_mask:0xf
    v_lshlrev_b32 v216, 16, v33
    v_and_b32 v217, 0xffff0000, v33
    v_sub_f32 v212, v42, v210
    v_sub_f32 v210, v34, v210
    v_exp_f32 v212, v212
    v_exp_f32 v210, v210
    v_lshlrev_b32 v218, 16, v36
    v_and_b32 v219, 0xffff0000, v36
    v_add_f32 v211, v210, v212
    v_lshlrev_b32 v220, 16, v37
    v_and_b32 v221, 0xffff0000, v37
    v_add_f32_dpp v211, v211, v211 quad_perm:[2,3,0,1] row_mask:0xf bank_mask:0xf
    v_lshlrev_b32 v48, 16, v40
    v_and_b32 v49, 0xffff0000, v40
    v_rcp_f32 v211, v211
    v_lshlrev_b32 v50, 16, v41
    v_and_b32 v51, 0xffff0000, v41
    v_mul_f32 v210, v210, v211
    v_mul_f32 v212, v212, v211
    v_lshlrev_b32 v52, 16, v44
    v_and_b32 v53, 0xffff0000, v44
    v_lshlrev_b32 v54, 16, v45
    v_and_b32 v55, 0xffff0000, v45
    v_pk_mul_f32 v[214:215], v[214:215], v[210:211] op_sel_hi:[1,0]
    v_pk_mul_f32 v[216:217], v[216:217], v[210:211] op_sel_hi:[1,0]
    v_pk_mul_f32 v[218:219], v[218:219], v[210:211] op_sel_hi:[1,0]
    v_pk_mul_f32 v[220:221], v[220:221], v[210:211] op_sel_hi:[1,0]
    v_pk_fma_f32 v[214:215], v[48:49], v[212:213], v[214:215] op_sel_hi:[1,0,1]
    v_pk_fma_f32 v[216:217], v[50:51], v[212:213], v[216:217] op_sel_hi:[1,0,1]
    v_pk_fma_f32 v[218:219], v[52:53], v[212:213], v[218:219] op_sel_hi:[1,0,1]
    v_pk_fma_f32 v[220:221], v[54:55], v[212:213], v[220:221] op_sel_hi:[1,0,1]
    v_add_f32_dpp v214, v214, v214 quad_perm:[2,3,0,1] row_mask:0xf bank_mask:0xf
    v_add_f32_dpp v215, v215, v215 quad_perm:[2,3,0,1] row_mask:0xf bank_mask:0xf
    v_add_f32_dpp v216, v216, v216 quad_perm:[2,3,0,1] row_mask:0xf bank_mask:0xf
    v_add_f32_dpp v217, v217, v217 quad_perm:[2,3,0,1] row_mask:0xf bank_mask:0xf
    v_add_f32_dpp v218, v218, v218 quad_perm:[2,3,0,1] row_mask:0xf bank_mask:0xf
    v_add_f32_dpp v219, v219, v219 quad_perm:[2,3,0,1] row_mask:0xf bank_mask:0xf
    v_add_f32_dpp v220, v220, v220 quad_perm:[2,3,0,1] row_mask:0xf bank_mask:0xf
    v_add_f32_dpp v221, v221, v221 quad_perm:[2,3,0,1] row_mask:0xf bank_mask:0xf
    v_cvt_pk_bf16_f32 v222, v214, v215
    v_cvt_pk_bf16_f32 v223, v216, v217
L_pad_13:
    s_cbranch_execz L_warm_done
    v_cvt_pk_bf16_f32 v224, v218, v219
    v_cvt_pk_bf16_f32 v225, v220, v221
    s_nop 1
    v_mfma_f32_16x16x32_bf16 v[96:99], v[222:225], v[160:163], 0
    v_mfma_f32_16x16x32_bf16 v[112:115], v[222:225], v[176:179], 0
    v_mfma_f32_16x16x32_bf16 v[100:103], v[222:225], v[164:167], 0
    v_mfma_f32_16x16x32_bf16 v[116:119], v[222:225], v[180:183], 0
    v_mfma_f32_16x16x32_bf16 v[104:107], v[222:225], v[168:171], 0
    v_mfma_f32_16x16x32_bf16 v[120:123], v[222:225], v[184:187], 0
    v_mfma_f32_16x16x32_bf16 v[108:111], v[222:225], v[172:175], 0
    v_mfma_f32_16x16x32_bf16 v[124:127], v[222:225], v[188:191], 0
    v_mov_b32 v213, v2
    v_add_f32_dpp v214, v97, v96 row_ror:8 row_mask:0xf bank_mask:0x3
    v_add_f32_dpp v214, v112, v113 row_ror:8 row_mask:0xf bank_mask:0xc
    v_add_f32_dpp v215, v101, v100 row_ror:8 row_mask:0xf bank_mask:0x3
    v_add_f32_dpp v215, v116, v117 row_ror:8 row_mask:0xf bank_mask:0xc
    v_add_f32_dpp v216, v105, v104 row_ror:8 row_mask:0xf bank_mask:0x3
    v_add_f32_dpp v216, v120, v121 row_ror:8 row_mask:0xf bank_mask:0xc
    v_add_f32_dpp v217, v109, v108 row_ror:8 row_mask:0xf bank_mask:0x3
    v_add_f32_dpp v217, v124, v125 row_ror:8 row_mask:0xf bank_mask:0xc
    ds_write_b128 v25, v[214:217] offset:0
    s_waitcnt lgkmcnt(0)
    s_barrier
    ds_read_b128 v[214:217], v7 offset:0
    ds_read_b128 v[218:221], v7 offset:1024
    ds_read_b128 v[222:225], v7 offset:2048
    ds_read_b128 v[226:229], v7 offset:3072
    s_lshl_b32 s59, s3, 18
    s_add_u32 s7, s59, 0x20000
    s_waitcnt lgkmcnt(0)
    v_pk_add_f32 v[214:215], v[214:215], v[218:219]
    v_pk_add_f32 v[216:217], v[216:217], v[220:221]
    v_pk_add_f32 v[222:223], v[222:223], v[226:227]
    v_pk_add_f32 v[224:225], v[224:225], v[228:229]
    v_pk_add_f32 v[214:215], v[214:215], v[222:223]
    v_pk_add_f32 v[216:217], v[216:217], v[224:225]
    v_perm_b32 v211, v215, v217, s65
    v_perm_b32 v212, v216, v217, s66
    v_perm_b32 v210, v214, v217, s64
    buffer_store_dwordx4 v[210:213], v24, s[8:11], s59 offen sc1
    buffer_store_dwordx4 v[210:213], v24, s[8:11], s7 offen sc1
L_A_red:
    s_mov_b32 s64, 0x0c04000c
    s_mov_b32 s65, 0x04020100
    v_and_b32 v10, 16, v0
    v_lshlrev_b32 v206, 16, v206
    v_mov_b32 v216, 0
    v_mov_b32 v217, v2
    s_mov_b32 exec_lo, 0xff
    s_mov_b32 exec_hi, 0x0
    s_sub_u32 s34, s58, 128
    s_branch L_poll_18_ld
L_poll_18:
    s_cmp_lg_u32 s34, s58
    s_cbranch_scc1 L_poll_18_ld
    s_mov_b64 s[70:71], exec
    s_mov_b64 exec, -1
    s_mov_b32 exec_lo, 0x55555555
    s_mov_b32 exec_hi, 0x55555555
    buffer_store_dwordx4 v[12:15], v22, s[8:11], 0 offen sc1
    s_mov_b64 exec, -1
    s_mov_b64 exec, s[70:71]
    s_mov_b32 s34, -1
L_poll_18_ld:
    buffer_load_dwordx4 v[96:99], v237, s[8:11], 0 offen offset:0 sc1
    s_sub_u32 s58, s58, 1
    s_cbranch_scc1 L_end
L_chk_19:
    s_waitcnt vmcnt(0)
L_chk_19_w:
    v_cmp_ne_u32 vcc, v99, v2
    s_cbranch_vccnz L_poll_18
    s_mov_b64 exec, -1
    s_sub_u32 s34, s58, 128
    s_branch L_poll_20_ld
L_poll_20:
    s_cmp_lg_u32 s34, s58
    s_cbranch_scc1 L_poll_20_ld
    s_mov_b64 s[70:71], exec
    s_mov_b64 exec, -1
    s_mov_b32 exec_lo, 0x55555555
    s_mov_b32 exec_hi, 0x55555555
    buffer_store_dwordx4 v[12:15], v22, s[8:11], 0 offen sc1
    s_mov_b64 exec, -1
    s_mov_b64 exec, s[70:71]
    s_mov_b32 s34, -1
L_poll_20_ld:
    buffer_load_dwordx4 v[96:99], v237, s[8:11], 0 offen offset:0 sc1
    buffer_load_dwordx4 v[100:103], v237, s[8:11], 0 offen offset:1024 sc1
    buffer_load_dwordx4 v[56:59], v239, s[8:11], 0 offen offset:0 sc1
    s_sub_u32 s58, s58, 1
    s_cbranch_scc1 L_end
L_chk_21:
    s_waitcnt vmcnt(0)
L_chk_21_w:
    v_min3_u32 v8, v99, v103, v59
    v_max3_u32 v9, v99, v103, v59
    v_cmp_ne_u32 vcc, v8, v2
    v_cmp_ne_u32 s[70:71], v9, v2
    s_or_b64 vcc, vcc, s[70:71]
    s_cbranch_vccnz L_poll_20
    v_perm_b32 v99, v97, v96, s64
    v_perm_b32 v99, v98, v99, s65
    v_perm_b32 v103, v101, v100, s64
    v_perm_b32 v103, v102, v103, s65
    v_pk_add_f32 v[32:33], v[96:97], v[100:101]
    v_pk_add_f32 v[34:35], v[98:99], v[102:103]
    s_mov_b32 vcc_lo, 0
    s_mov_b32 vcc_hi, -1
    v_permlane32_swap_b32 v32, v34
    v_permlane32_swap_b32 v33, v35
    v_add_f32 v32, v32, v34
    v_add_f32 v33, v33, v35
    v_cndmask_b32 v56, v56, v57, vcc
    v_lshrrev_b32 v56, v10, v56
    v_permlane16_swap_b32 v32, v33
    v_add_f32 v210, v32, v33
    v_lshlrev_b32 v202, 16, v56
    s_nop 0
    v_add_f32_dpp v210, v210, v210 row_ror:8 row_mask:0xf bank_mask:0xf
    v_cvt_pk_bf16_f32 v210, v210, v210
    v_lshlrev_b32 v210, 16, v210
    v_mul_f32 v210, v210, v202
    v_cvt_pk_bf16_f32 v210, v210, v210
    v_lshlrev_b32 v210, 16, v210
    v_add_f32 v210, v210, v206
    v_cvt_pk_bf16_f32 v210, v210, v210
    v_mov_b32 v211, v210
    v_lshlrev_b32 v208, 16, v210
    s_nop 0
    v_permlane16_swap_b32 v210, v211
    v_perm_b32 v214, v211, v210, s56
    v_perm_b32 v215, v211, v210, s56
    s_nop 1
    v_permlane32_swap_b32 v214, v215
    s_mov_b32 exec_lo, 0xff
    s_mov_b32 exec_hi, 0x0
    buffer_store_dwordx4 v[214:217], v238, s[8:11], s50 offen
    buffer_store_dwordx4 v[214:217], v238, s[8:11], 0 offen sc1
    s_mov_b64 exec, -1
    s_mov_b32 exec_lo, 0x55555555
    s_mov_b32 exec_hi, 0x55555555
    buffer_store_dwordx4 v[12:15], v22, s[8:11], 0 offen sc1
    s_mov_b64 exec, -1
    s_cmp_lg_u32 s5, s51
    s_cbranch_scc1 L_end
L_poll_22:
    buffer_load_dwordx4 v[56:59], v240, s[8:11], 0 offen offset:0 sc1
    s_sub_u32 s58, s58, 1
    s_cbranch_scc1 L_end
L_chk_23:
    s_waitcnt vmcnt(0)
L_chk_23_w:
    v_cmp_ne_u32 vcc, v59, v2
    s_cbranch_vccnz L_poll_22
    s_mov_b32 vcc_lo, 0
    s_mov_b32 vcc_hi, -1
    v_cndmask_b32 v56, v56, v57, vcc
    v_lshrrev_b32 v56, v10, v56
    v_lshlrev_b32 v204, 16, v56
    s_lshl_b32 s7, s5, 7
    s_add_u32 s7, s7, 0x3e0000
    v_mov_b32 v8, 0
    s_movk_i32 s59, 128
    s_mov_b64 exec, 1
L_fw_24:
    buffer_load_dword v9, v8, s[8:11], s7 offen sc1
    s_sub_u32 s59, s59, 1
    s_cbranch_scc1 L_fx_25
    s_waitcnt vmcnt(0)
    v_cmp_ne_u32 vcc, v9, v2
    s_cbranch_vccnz L_fw_24
L_fx_25:
    s_mov_b64 exec, -1
    s_waitcnt vmcnt(0)
L_pg_26:
    buffer_load_dwordx4 v[36:39], v234, s[8:11], 0 offen offset:0 sc1
    buffer_load_dwordx4 v[40:43], v234, s[8:11], 0 offen offset:1024 sc1
    buffer_load_dwordx4 v[44:47], v234, s[8:11], 0 offen offset:2048 sc1
    buffer_load_dwordx4 v[48:51], v234, s[8:11], 0 offen offset:3072 sc1
    buffer_load_dwordx4 v[52:55], v235, s[8:11], 0 offen offset:0 sc1
    buffer_load_dwordx4 v[56:59], v235, s[8:11], 0 offen offset:1024 sc1
    buffer_load_dwordx4 v[60:63], v235, s[8:11], 0 offen offset:2048 sc1
    s_waitcnt vmcnt(0)
    v_min3_u32 v8, v39, v43, v47
    v_max3_u32 v9, v39, v43, v47
    v_min3_u32 v8, v8, v51, v55
    v_max3_u32 v9, v9, v51, v55
    v_min3_u32 v8, v8, v59, v63
    v_max3_u32 v9, v9, v59, v63
    v_cmp_ne_u32 vcc, v8, v2
    v_cmp_ne_u32 s[70:71], v9, v2
    s_or_b64 vcc, vcc, s[70:71]
    v_perm_b32 v39, v37, v36, s64
    v_perm_b32 v39, v38, v39, s65
    v_perm_b32 v43, v41, v40, s64
L_pad_14:
    s_cbranch_execz L_warm_done
    v_perm_b32 v43, v42, v43, s65
    v_perm_b32 v47, v45, v44, s64
    v_perm_b32 v47, v46, v47, s65
    v_perm_b32 v51, v49, v48, s64
    v_perm_b32 v51, v50, v51, s65
    v_perm_b32 v55, v53, v52, s64
    v_perm_b32 v55, v54, v55, s65
    v_perm_b32 v59, v57, v56, s64
    v_perm_b32 v59, v58, v59, s65
    v_perm_b32 v63, v61, v60, s64
    v_perm_b32 v63, v62, v63, s65
    v_pk_add_f32 v[36:37], v[36:37], v[40:41]
    v_pk_add_f32 v[38:39], v[38:39], v[42:43]
    v_pk_add_f32 v[44:45], v[44:45], v[48:49]
    v_pk_add_f32 v[46:47], v[46:47], v[50:51]
    v_pk_add_f32 v[52:53], v[52:53], v[56:57]
    v_pk_add_f32 v[54:55], v[54:55], v[58:59]
    v_pk_add_f32 v[36:37], v[36:37], v[44:45]
    v_pk_add_f32 v[38:39], v[38:39], v[46:47]
    v_pk_add_f32 v[52:53], v[52:53], v[60:61]
    v_pk_add_f32 v[54:55], v[54:55], v[62:63]
    v_pk_add_f32 v[32:33], v[36:37], v[52:53]
    v_pk_add_f32 v[34:35], v[38:39], v[54:55]
    s_cbranch_vccz L_pgd_27
    s_sub_u32 s58, s58, 1
    s_cbranch_scc0 L_pg_26
    s_branch L_end
L_pgd_27:
    s_nop 1
    v_permlane32_swap_b32 v32, v34
    v_permlane32_swap_b32 v33, v35
    v_add_f32 v32, v32, v34
    v_add_f32 v33, v33, v35
    s_nop 1
    v_permlane16_swap_b32 v32, v33
    v_add_f32 v210, v32, v33
    s_nop 1
    v_add_f32_dpp v210, v210, v210 row_ror:8 row_mask:0xf bank_mask:0xf
    v_cvt_pk_bf16_f32 v210, v210, v210
    v_lshlrev_b32 v210, 16, v210
    v_mul_f32 v210, v210, v204
    v_cvt_pk_bf16_f32 v210, v210, v210
    v_lshlrev_b32 v210, 16, v210
    v_add_f32 v210, v210, v208
    v_cvt_pk_bf16_f32 v210, v210, v210
    s_mov_b32 exec_lo, 0xff00ff
    s_mov_b32 exec_hi, 0xff00ff
    buffer_store_short v210, v236, s[52:55], s60 offen
    s_cmp_lg_u32 s63, 0
    s_cbranch_scc1 L_end
    s_mov_b32 exec_lo, 0x1
    s_mov_b32 exec_hi, 0x0
    v_mov_b32 v8, 0
    buffer_store_dword v2, v8, s[8:11], 0 offen
    s_branch L_end
L_end:
L_exit:
    s_endpgm
.section .rodata,"a"
.p2align 6
.amdhsa_kernel adaLN_cond__sliding_block_cached__glu_gated_swiglu__decode_kernel
  .amdhsa_next_free_vgpr 340
  .amdhsa_next_free_sgpr 102
  .amdhsa_accum_offset 244
  .amdhsa_group_segment_fixed_size 0
  .amdhsa_kernarg_size 112
  .amdhsa_user_sgpr_count 2
  .amdhsa_user_sgpr_kernarg_segment_ptr 1
  .amdhsa_system_sgpr_workgroup_id_x 1
.end_amdhsa_kernel
```
